```python
import torch

def _softmax(x, axis=-1):
    return torch.softmax(x, dim=axis)

def _gelu(x):
    return torch.nn.functional.gelu(x, approximate='tanh')

def _silu(x):
    return torch.nn.functional.silu(x)

def _sigmoid(x):
    return torch.sigmoid(x)

def _layernorm(x, axis=-1, eps=1e-05):
    m = x.mean(dim=axis, keepdim=True)
    v = x.var(dim=axis, keepdim=True, unbiased=False)
    return (x - m) / torch.sqrt(v + eps)

def _scatter_add(tgt, idx, src, axis=0):
    return tgt.clone().index_add_(axis, idx, src)

def _segment_sum(src, seg, n):
    out = torch.zeros((n,) + src.shape[1:], dtype=src.dtype)
    return out.index_add_(0, seg, src)

def _pad(x, pw):
    flat = tuple((v for pair in reversed(pw) for v in pair))
    return torch.nn.functional.pad(x, flat)
kernel_name = 'standalone__tree_speculative_verify_tree_attention_over_candidate_token_tree__sampling'

def setup_inputs():

    _w = lambda a: (lambda t: t.to(torch.bfloat16) if t.is_floating_point() else t)(torch.as_tensor(a))
    B, Hq, Hkv, T, C, D = (32, 32, 8, 8, 2048, 128)
    tree_mask = torch.zeros((B, T, T), dtype=float)
    for b in range(B):
        parent = torch.zeros(T, dtype=torch.int64)
        for i in range(1, T):
            parent[i] = int(torch.randint(0, i, (1,)).item())
        for i in range(T):
            j = i
            tree_mask[b, i, j] = 1.0
            while j > 0:
                j = parent[j]
                tree_mask[b, i, j] = 1.0
    return {'q': _w((lambda *s: torch.randn(*s, dtype=torch.bfloat16) * 0.8)(B, Hq, T, D)), 'k_cache': _w((lambda *s: torch.randn(*s, dtype=torch.bfloat16) * 0.8)(B, Hkv, C, D)), 'v_cache': _w((lambda *s: torch.randn(*s, dtype=torch.bfloat16) * 0.05)(B, Hkv, C, D)), 'k_tree': _w((lambda *s: torch.randn(*s, dtype=torch.bfloat16) * 0.8)(B, Hkv, T, D)), 'v_tree': _w((lambda *s: torch.randn(*s, dtype=torch.bfloat16) * 0.05)(B, Hkv, T, D)), 'tree_mask': _w(tree_mask)}

def reference(q, k_cache, v_cache, k_tree, v_tree, tree_mask):
    B, Hq, T, D = q.shape
    Hkv, C = (k_cache.shape[1], k_cache.shape[2])
    rep = Hq // Hkv
    kc = (lambda x, n, axis: torch.repeat_interleave(x, n, dim=axis))(k_cache, rep, axis=1)
    vc = (lambda x, n, axis: torch.repeat_interleave(x, n, dim=axis))(v_cache, rep, axis=1)
    kt = (lambda x, n, axis: torch.repeat_interleave(x, n, dim=axis))(k_tree, rep, axis=1)
    vt = (lambda x, n, axis: torch.repeat_interleave(x, n, dim=axis))(v_tree, rep, axis=1)
    k = torch.concatenate([kc, kt], axis=2)
    v = torch.concatenate([vc, vt], axis=2)
    scale = D ** (-0.5)
    scores = torch.einsum('bhqd,bhkd->bhqk', q, k) * scale
    ctx_mask = torch.ones((B, 1, T, C), dtype=scores.dtype)
    tm = tree_mask[:, None, :, :].clone()
    full_mask = torch.concatenate([ctx_mask, tm], axis=-1)
    scores = scores + (1.0 - full_mask) * -1000000000.0
    p = _softmax(scores, axis=-1)
    return torch.einsum('bhqk,bhkd->bhqd', p, v)
```

```asm
; @launch grid=(256,1,1) block=(512,1,1) lds=137216
.amdgcn_target "amdgcn-amd-amdhsa--gfx950"
.text
.globl standalone__tree_speculative_verify_tree_attention_over_candidate_token_tree__sampling_kernel
.p2align 8
.type standalone__tree_speculative_verify_tree_attention_over_candidate_token_tree__sampling_kernel,@function
standalone__tree_speculative_verify_tree_attention_over_candidate_token_tree__sampling_kernel:
    s_cmp_ge_u32 s2, 256
    s_cbranch_scc1 L_end
    s_load_dwordx16 s[36:51], s[0:1], 0
    s_bitcmp1_b32 s2, 0
    s_cbranch_scc0 L_rm0
    s_xor_b32 s2, s2, 36
L_rm0:
    s_bitcmp1_b32 s2, 1
    s_cbranch_scc0 L_rm1
    s_xor_b32 s2, s2, 25
L_rm1:
    s_bitcmp1_b32 s2, 2
    s_cbranch_scc0 L_rm2
    s_xor_b32 s2, s2, 26
L_rm2:
    s_bitcmp1_b32 s2, 3
    s_cbranch_scc0 L_rm3
    s_xor_b32 s2, s2, 48
L_rm3:
    s_bitcmp1_b32 s2, 4
    s_cbranch_scc0 L_rm4
    s_xor_b32 s2, s2, 46
L_rm4:
    s_bitcmp1_b32 s2, 5
    s_cbranch_scc0 L_rm5
    s_xor_b32 s2, s2, 22
L_rm5:
    s_bitcmp1_b32 s2, 0
    s_cbranch_scc0 L_rm6
    s_xor_b32 s2, s2, 34
L_rm6:
    s_bitcmp1_b32 s2, 1
    s_cbranch_scc0 L_rm7
    s_xor_b32 s2, s2, 53
L_rm7:
    s_bitcmp1_b32 s2, 2
    s_cbranch_scc0 L_rm8
    s_xor_b32 s2, s2, 34
L_rm8:
    s_bitcmp1_b32 s2, 3
    s_cbranch_scc0 L_rm9
    s_xor_b32 s2, s2, 6
L_rm9:
    s_bitcmp1_b32 s2, 4
    s_cbranch_scc0 L_rm10
    s_xor_b32 s2, s2, 36
L_rm10:
    s_bitcmp1_b32 s2, 5
    s_cbranch_scc0 L_rm11
    s_xor_b32 s2, s2, 7
L_rm11:
    s_bitcmp1_b32 s2, 6
    s_cbranch_scc0 L_rm12
    s_xor_b32 s2, s2, 4
L_rm12:
    s_bitcmp1_b32 s2, 7
    s_cbranch_scc0 L_rm13
    s_xor_b32 s2, s2, 43
L_rm13:
    s_and_b32 s4, s2, 1
    s_lshl_b32 s4, s4, 7
    s_xor_b32 s2, s2, s4
    v_lshrrev_b32 v14, 6, v0
    v_and_b32 v15, 63, v0
    v_readfirstlane_b32 s3, v14
    v_lshlrev_b32 v2, 4, v15
    v_lshrrev_b32 v22, 4, v15
    v_lshlrev_b32 v23, 4, v22
    v_and_b32 v20, 14, v15
    v_or_b32 v20, 0, v20
    v_and_b32 v21, 3, v20
    v_lshlrev_b32 v21, 10, v21
    v_bfe_u32 v20, v20, 2, 2
    v_lshl_add_u32 v21, v20, 8, v21
    v_and_b32 v20, 1, v15
    v_xor_b32 v20, 0, v20
    v_lshl_add_u32 v21, v20, 6, v21
    v_add_u32 v1, v21, v23
    v_and_b32 v20, 14, v15
    v_or_b32 v20, 1, v20
    v_and_b32 v21, 3, v20
    v_lshlrev_b32 v21, 10, v21
    v_bfe_u32 v20, v20, 2, 2
    v_lshl_add_u32 v21, v20, 8, v21
    v_and_b32 v20, 1, v15
    v_xor_b32 v20, 1, v20
    v_lshl_add_u32 v21, v20, 6, v21
    v_add_u32 v5, v21, v23
    v_and_b32 v20, 15, v15
    v_lshl_add_u32 v10, v20, 8, v23
    v_and_b32 v20, 7, v15
    v_lshlrev_b32 v21, 1, v22
    v_lshl_add_u32 v11, v20, 4, v21
    s_mov_b32 s52, 0x3e0293ee
    s_mov_b32 s53, 0x05040100
    s_mov_b32 s54, 0x07060302
    s_mov_b32 s55, 4096
    s_mov_b32 s60, 0xd028965f
    s_mov_b32 s62, 0xaaaaaaaa
    s_mov_b32 s63, 0xaaaaaaaa
    s_lshl_b32 s58, s2, 19
    s_lshl_b32 s59, s3, 12
    s_add_u32 s58, s58, s59
    s_mov_b32 s56, 0
    s_mov_b32 s57, 0
    s_waitcnt lgkmcnt(0)
    s_add_u32 s12, s38, s58
    s_addc_u32 s13, s39, 0
    s_mov_b32 s14, 495616
    s_mov_b32 s15, 0x00020000
    s_add_u32 s16, s40, s58
    s_addc_u32 s17, s41, 0
    s_mov_b32 s18, 495616
    s_mov_b32 s19, 0x00020000
    s_lshl_b32 s58, s2, 13
    s_add_u32 s8, s36, s58
    s_addc_u32 s9, s37, 0
    s_mov_b32 s10, 8192
    s_mov_b32 s11, 0x00020000
    s_add_u32 s32, s48, s58
    s_addc_u32 s33, s49, 0
    s_mov_b32 s34, 8192
    s_mov_b32 s35, 0x00020000
    s_lshl_b32 s58, s2, 11
    s_add_u32 s20, s42, s58
    s_addc_u32 s21, s43, 0
    s_mov_b32 s22, 2048
    s_mov_b32 s23, 0x00020000
    s_add_u32 s24, s44, s58
    s_addc_u32 s25, s45, 0
    s_mov_b32 s26, 2048
    s_mov_b32 s27, 0x00020000
    s_lshr_b32 s58, s2, 3
    s_lshl_b32 s58, s58, 7
    s_add_u32 s28, s46, s58
    s_addc_u32 s29, s47, 0
    s_mov_b32 s30, 128
    s_mov_b32 s31, 0x00020000
    buffer_load_dwordx4 v[16:19], v10, s[8:11], 0 offen offset:0
    buffer_load_dwordx4 v[20:23], v10, s[8:11], 0 offen offset:64
    buffer_load_dwordx4 v[24:27], v10, s[8:11], 0 offen offset:128
    buffer_load_dwordx4 v[28:31], v10, s[8:11], 0 offen offset:192
    buffer_load_dwordx4 v[32:35], v10, s[8:11], s55 offen offset:0
    buffer_load_dwordx4 v[36:39], v10, s[8:11], s55 offen offset:64
    buffer_load_dwordx4 v[40:43], v10, s[8:11], s55 offen offset:128
    buffer_load_dwordx4 v[44:47], v10, s[8:11], s55 offen offset:192
    buffer_load_dwordx4 v[176:179], v1, s[20:23], 0 offen offset:0
    buffer_load_dwordx4 v[180:183], v5, s[20:23], 0 offen offset:0
    buffer_load_dwordx4 v[184:187], v1, s[20:23], 0 offen offset:128
    buffer_load_dwordx4 v[188:191], v5, s[20:23], 0 offen offset:128
    buffer_load_ushort v3, v11, s[28:31], 0 offen
    buffer_load_ushort v4, v11, s[28:31], 0 offen offset:8
    buffer_load_dwordx4 v[192:195], v1, s[12:15], s56 offen offset:0 nt
    buffer_load_dwordx4 v[196:199], v5, s[12:15], s56 offen offset:0 nt
    buffer_load_dwordx4 v[200:203], v1, s[12:15], s56 offen offset:128 nt
    buffer_load_dwordx4 v[204:207], v5, s[12:15], s56 offen offset:128 nt
    s_add_u32 s56, s56, 32768
    buffer_load_dwordx4 v[208:211], v1, s[12:15], s56 offen offset:0 nt
    buffer_load_dwordx4 v[212:215], v5, s[12:15], s56 offen offset:0 nt
    buffer_load_dwordx4 v[216:219], v1, s[12:15], s56 offen offset:128 nt
    buffer_load_dwordx4 v[220:223], v5, s[12:15], s56 offen offset:128 nt
    s_add_u32 s56, s56, 32768
    buffer_load_dwordx4 v[224:227], v1, s[12:15], s56 offen offset:0 nt
    buffer_load_dwordx4 v[228:231], v5, s[12:15], s56 offen offset:0 nt
    buffer_load_dwordx4 v[232:235], v1, s[12:15], s56 offen offset:128 nt
    buffer_load_dwordx4 v[236:239], v5, s[12:15], s56 offen offset:128 nt
    s_add_u32 s56, s56, 32768
    s_waitcnt vmcnt(18)
    s_waitcnt vmcnt(12)
    s_mov_b64 exec, s[62:63]
    v_swap_b32 v176, v180
    v_swap_b32 v177, v181
    v_swap_b32 v178, v182
    v_swap_b32 v179, v183
    v_swap_b32 v184, v188
    v_swap_b32 v185, v189
    v_swap_b32 v186, v190
    v_swap_b32 v187, v191
    s_mov_b64 exec, -1
    s_nop 1
    v_mfma_f32_16x16x32_bf16 v[160:163], v[176:179], v[16:19], 0
    v_mfma_f32_16x16x32_bf16 v[160:163], v[184:187], v[24:27], v[160:163]
    v_mfma_f32_16x16x32_bf16 v[168:171], v[180:183], v[20:23], 0
    v_mfma_f32_16x16x32_bf16 v[168:171], v[188:191], v[28:31], v[168:171]
    v_mfma_f32_16x16x32_bf16 v[164:167], v[176:179], v[32:35], 0
    v_mfma_f32_16x16x32_bf16 v[164:167], v[184:187], v[40:43], v[164:167]
    v_mfma_f32_16x16x32_bf16 v[172:175], v[180:183], v[36:39], 0
    v_mfma_f32_16x16x32_bf16 v[172:175], v[188:191], v[44:47], v[172:175]
    buffer_load_dwordx4 v[176:179], v1, s[12:15], s56 offen offset:0 nt
    buffer_load_dwordx4 v[180:183], v5, s[12:15], s56 offen offset:0 nt
    buffer_load_dwordx4 v[184:187], v1, s[12:15], s56 offen offset:128 nt
    buffer_load_dwordx4 v[188:191], v5, s[12:15], s56 offen offset:128 nt
    s_add_u32 s56, s56, 32768
    v_lshlrev_b32 v3, 16, v3
    v_lshlrev_b32 v4, 16, v4
    v_sub_f32 v3, 1.0, v3
    v_sub_f32 v4, 1.0, v4
    v_mul_f32 v3, s60, v3
    v_mul_f32 v4, s60, v4
    s_cmp_eq_u32 s3, 0
    s_cbranch_scc1 L_w0
    v_mov_b32 v3, 0xff800000
    v_mov_b32 v4, 0xff800000
L_w0:
    s_nop 4
    v_add_f32 v160, v160, v169
    v_add_f32 v161, v161, v168
    v_add_f32 v164, v164, v173
    v_add_f32 v165, v165, v172
    v_add_f32 v6, v160, v3
    v_add_f32 v7, v161, v4
    v_add_f32 v8, v164, v3
    v_add_f32 v9, v165, v4
    s_waitcnt vmcnt(12)
    s_mov_b64 exec, s[62:63]
    v_swap_b32 v192, v196
    v_swap_b32 v193, v197
    v_swap_b32 v194, v198
    v_swap_b32 v195, v199
    v_swap_b32 v200, v204
    v_swap_b32 v201, v205
    v_swap_b32 v202, v206
    v_swap_b32 v203, v207
    s_mov_b64 exec, -1
    s_nop 1
    v_mfma_f32_16x16x32_bf16 v[48:51], v[192:195], v[16:19], 0
    v_mfma_f32_16x16x32_bf16 v[48:51], v[200:203], v[24:27], v[48:51]
    v_mfma_f32_16x16x32_bf16 v[240:243], v[196:199], v[20:23], 0
    v_mfma_f32_16x16x32_bf16 v[240:243], v[204:207], v[28:31], v[240:243]
    v_mfma_f32_16x16x32_bf16 v[56:59], v[192:195], v[32:35], 0
    v_mfma_f32_16x16x32_bf16 v[56:59], v[200:203], v[40:43], v[56:59]
    v_mfma_f32_16x16x32_bf16 v[244:247], v[196:199], v[36:39], 0
    v_mfma_f32_16x16x32_bf16 v[244:247], v[204:207], v[44:47], v[244:247]
    buffer_load_dwordx4 v[192:195], v1, s[12:15], s56 offen offset:0 nt
    buffer_load_dwordx4 v[196:199], v5, s[12:15], s56 offen offset:0 nt
    buffer_load_dwordx4 v[200:203], v1, s[12:15], s56 offen offset:128 nt
    buffer_load_dwordx4 v[204:207], v5, s[12:15], s56 offen offset:128 nt
    s_add_u32 s56, s56, 32768
    s_waitcnt vmcnt(12)
    s_mov_b64 exec, s[62:63]
    v_swap_b32 v208, v212
    v_swap_b32 v209, v213
    v_swap_b32 v210, v214
    v_swap_b32 v211, v215
    v_swap_b32 v216, v220
    v_swap_b32 v217, v221
    v_swap_b32 v218, v222
    v_swap_b32 v219, v223
    s_mov_b64 exec, -1
    s_nop 1
    v_mfma_f32_16x16x32_bf16 v[52:55], v[208:211], v[16:19], 0
    v_mfma_f32_16x16x32_bf16 v[52:55], v[216:219], v[24:27], v[52:55]
    v_mfma_f32_16x16x32_bf16 v[248:251], v[212:215], v[20:23], 0
    v_mfma_f32_16x16x32_bf16 v[248:251], v[220:223], v[28:31], v[248:251]
    v_mfma_f32_16x16x32_bf16 v[60:63], v[208:211], v[32:35], 0
    v_mfma_f32_16x16x32_bf16 v[60:63], v[216:219], v[40:43], v[60:63]
    v_mfma_f32_16x16x32_bf16 v[252:255], v[212:215], v[36:39], 0
    v_mfma_f32_16x16x32_bf16 v[252:255], v[220:223], v[44:47], v[252:255]
    v_add_f32 v48, v48, v241
    v_add_f32 v49, v49, v240
    v_add_f32 v50, v50, v243
    v_add_f32 v51, v51, v242
    v_add_f32 v56, v56, v245
    v_add_f32 v57, v57, v244
    v_add_f32 v58, v58, v247
    v_add_f32 v59, v59, v246
    buffer_load_dwordx4 v[208:211], v1, s[12:15], s56 offen offset:0 nt
    buffer_load_dwordx4 v[212:215], v5, s[12:15], s56 offen offset:0 nt
    buffer_load_dwordx4 v[216:219], v1, s[12:15], s56 offen offset:128 nt
    buffer_load_dwordx4 v[220:223], v5, s[12:15], s56 offen offset:128 nt
    s_add_u32 s56, s56, 32768
    s_waitcnt vmcnt(12)
    s_mov_b64 exec, s[62:63]
    v_swap_b32 v224, v228
    v_swap_b32 v225, v229
    v_swap_b32 v226, v230
    v_swap_b32 v227, v231
    v_swap_b32 v232, v236
    v_swap_b32 v233, v237
    v_swap_b32 v234, v238
    v_swap_b32 v235, v239
    s_mov_b64 exec, -1
    s_nop 1
    v_mfma_f32_16x16x32_bf16 v[64:67], v[224:227], v[16:19], 0
    v_mfma_f32_16x16x32_bf16 v[64:67], v[232:235], v[24:27], v[64:67]
    v_mfma_f32_16x16x32_bf16 v[240:243], v[228:231], v[20:23], 0
    v_mfma_f32_16x16x32_bf16 v[240:243], v[236:239], v[28:31], v[240:243]
    v_mfma_f32_16x16x32_bf16 v[72:75], v[224:227], v[32:35], 0
    v_mfma_f32_16x16x32_bf16 v[72:75], v[232:235], v[40:43], v[72:75]
    v_mfma_f32_16x16x32_bf16 v[244:247], v[228:231], v[36:39], 0
    v_mfma_f32_16x16x32_bf16 v[244:247], v[236:239], v[44:47], v[244:247]
    v_add_f32 v52, v52, v249
    v_add_f32 v53, v53, v248
    v_add_f32 v54, v54, v251
    v_add_f32 v55, v55, v250
    v_add_f32 v60, v60, v253
    v_add_f32 v61, v61, v252
    v_add_f32 v62, v62, v255
    v_add_f32 v63, v63, v254
    buffer_load_dwordx4 v[224:227], v1, s[12:15], s56 offen offset:0 nt
    buffer_load_dwordx4 v[228:231], v5, s[12:15], s56 offen offset:0 nt
    buffer_load_dwordx4 v[232:235], v1, s[12:15], s56 offen offset:128 nt
    buffer_load_dwordx4 v[236:239], v5, s[12:15], s56 offen offset:128 nt
    s_add_u32 s56, s56, 32768
    s_waitcnt vmcnt(12)
    s_mov_b64 exec, s[62:63]
    v_swap_b32 v176, v180
    v_swap_b32 v177, v181
    v_swap_b32 v178, v182
    v_swap_b32 v179, v183
    v_swap_b32 v184, v188
    v_swap_b32 v185, v189
    v_swap_b32 v186, v190
    v_swap_b32 v187, v191
    s_mov_b64 exec, -1
    s_nop 1
    v_mfma_f32_16x16x32_bf16 v[68:71], v[176:179], v[16:19], 0
    v_mfma_f32_16x16x32_bf16 v[68:71], v[184:187], v[24:27], v[68:71]
    v_mfma_f32_16x16x32_bf16 v[248:251], v[180:183], v[20:23], 0
    v_mfma_f32_16x16x32_bf16 v[248:251], v[188:191], v[28:31], v[248:251]
    v_mfma_f32_16x16x32_bf16 v[76:79], v[176:179], v[32:35], 0
    v_mfma_f32_16x16x32_bf16 v[76:79], v[184:187], v[40:43], v[76:79]
    v_mfma_f32_16x16x32_bf16 v[252:255], v[180:183], v[36:39], 0
    v_mfma_f32_16x16x32_bf16 v[252:255], v[188:191], v[44:47], v[252:255]
    v_add_f32 v64, v64, v241
    v_add_f32 v65, v65, v240
    v_add_f32 v66, v66, v243
    v_add_f32 v67, v67, v242
    v_add_f32 v72, v72, v245
    v_add_f32 v73, v73, v244
    v_add_f32 v74, v74, v247
    v_add_f32 v75, v75, v246
    buffer_load_dwordx4 v[176:179], v1, s[12:15], s56 offen offset:0 nt
    buffer_load_dwordx4 v[180:183], v5, s[12:15], s56 offen offset:0 nt
    buffer_load_dwordx4 v[184:187], v1, s[12:15], s56 offen offset:128 nt
    buffer_load_dwordx4 v[188:191], v5, s[12:15], s56 offen offset:128 nt
    s_add_u32 s56, s56, 32768
    s_waitcnt vmcnt(12)
    s_mov_b64 exec, s[62:63]
    v_swap_b32 v192, v196
    v_swap_b32 v193, v197
    v_swap_b32 v194, v198
    v_swap_b32 v195, v199
    v_swap_b32 v200, v204
    v_swap_b32 v201, v205
    v_swap_b32 v202, v206
    v_swap_b32 v203, v207
    s_mov_b64 exec, -1
    s_nop 1
    v_mfma_f32_16x16x32_bf16 v[80:83], v[192:195], v[16:19], 0
    v_mfma_f32_16x16x32_bf16 v[80:83], v[200:203], v[24:27], v[80:83]
    v_mfma_f32_16x16x32_bf16 v[240:243], v[196:199], v[20:23], 0
    v_mfma_f32_16x16x32_bf16 v[240:243], v[204:207], v[28:31], v[240:243]
    v_mfma_f32_16x16x32_bf16 v[88:91], v[192:195], v[32:35], 0
    v_mfma_f32_16x16x32_bf16 v[88:91], v[200:203], v[40:43], v[88:91]
    v_mfma_f32_16x16x32_bf16 v[244:247], v[196:199], v[36:39], 0
    v_mfma_f32_16x16x32_bf16 v[244:247], v[204:207], v[44:47], v[244:247]
    v_add_f32 v68, v68, v249
    v_add_f32 v69, v69, v248
    v_add_f32 v70, v70, v251
    v_add_f32 v71, v71, v250
    v_add_f32 v76, v76, v253
    v_add_f32 v77, v77, v252
    v_add_f32 v78, v78, v255
    v_add_f32 v79, v79, v254
    buffer_load_dwordx4 v[192:195], v1, s[12:15], s56 offen offset:0 nt
    buffer_load_dwordx4 v[196:199], v5, s[12:15], s56 offen offset:0 nt
    buffer_load_dwordx4 v[200:203], v1, s[12:15], s56 offen offset:128 nt
    buffer_load_dwordx4 v[204:207], v5, s[12:15], s56 offen offset:128 nt
    s_add_u32 s56, s56, 32768
    s_waitcnt vmcnt(12)
    s_mov_b64 exec, s[62:63]
    v_swap_b32 v208, v212
    v_swap_b32 v209, v213
    v_swap_b32 v210, v214
    v_swap_b32 v211, v215
    v_swap_b32 v216, v220
    v_swap_b32 v217, v221
    v_swap_b32 v218, v222
    v_swap_b32 v219, v223
    s_mov_b64 exec, -1
    s_nop 1
    v_mfma_f32_16x16x32_bf16 v[84:87], v[208:211], v[16:19], 0
    v_mfma_f32_16x16x32_bf16 v[84:87], v[216:219], v[24:27], v[84:87]
    v_mfma_f32_16x16x32_bf16 v[248:251], v[212:215], v[20:23], 0
    v_mfma_f32_16x16x32_bf16 v[248:251], v[220:223], v[28:31], v[248:251]
    v_mfma_f32_16x16x32_bf16 v[92:95], v[208:211], v[32:35], 0
    v_mfma_f32_16x16x32_bf16 v[92:95], v[216:219], v[40:43], v[92:95]
    v_mfma_f32_16x16x32_bf16 v[252:255], v[212:215], v[36:39], 0
    v_mfma_f32_16x16x32_bf16 v[252:255], v[220:223], v[44:47], v[252:255]
    v_add_f32 v80, v80, v241
    v_add_f32 v81, v81, v240
    v_add_f32 v82, v82, v243
    v_add_f32 v83, v83, v242
    v_add_f32 v88, v88, v245
    v_add_f32 v89, v89, v244
    v_add_f32 v90, v90, v247
    v_add_f32 v91, v91, v246
    buffer_load_dwordx4 v[208:211], v1, s[12:15], s56 offen offset:0 nt
    buffer_load_dwordx4 v[212:215], v5, s[12:15], s56 offen offset:0 nt
    buffer_load_dwordx4 v[216:219], v1, s[12:15], s56 offen offset:128 nt
    buffer_load_dwordx4 v[220:223], v5, s[12:15], s56 offen offset:128 nt
    s_add_u32 s56, s56, 32768
    s_waitcnt vmcnt(12)
    s_mov_b64 exec, s[62:63]
    v_swap_b32 v224, v228
    v_swap_b32 v225, v229
    v_swap_b32 v226, v230
    v_swap_b32 v227, v231
    v_swap_b32 v232, v236
    v_swap_b32 v233, v237
    v_swap_b32 v234, v238
    v_swap_b32 v235, v239
    s_mov_b64 exec, -1
    s_nop 1
    v_mfma_f32_16x16x32_bf16 v[96:99], v[224:227], v[16:19], 0
    v_mfma_f32_16x16x32_bf16 v[96:99], v[232:235], v[24:27], v[96:99]
    v_mfma_f32_16x16x32_bf16 v[240:243], v[228:231], v[20:23], 0
    v_mfma_f32_16x16x32_bf16 v[240:243], v[236:239], v[28:31], v[240:243]
    v_mfma_f32_16x16x32_bf16 v[104:107], v[224:227], v[32:35], 0
    v_mfma_f32_16x16x32_bf16 v[104:107], v[232:235], v[40:43], v[104:107]
    v_mfma_f32_16x16x32_bf16 v[244:247], v[228:231], v[36:39], 0
    v_mfma_f32_16x16x32_bf16 v[244:247], v[236:239], v[44:47], v[244:247]
    v_add_f32 v84, v84, v249
    v_add_f32 v85, v85, v248
    v_add_f32 v86, v86, v251
    v_add_f32 v87, v87, v250
    v_add_f32 v92, v92, v253
    v_add_f32 v93, v93, v252
    v_add_f32 v94, v94, v255
    v_add_f32 v95, v95, v254
    buffer_load_dwordx4 v[224:227], v1, s[12:15], s56 offen offset:0 nt
    buffer_load_dwordx4 v[228:231], v5, s[12:15], s56 offen offset:0 nt
    buffer_load_dwordx4 v[232:235], v1, s[12:15], s56 offen offset:128 nt
    buffer_load_dwordx4 v[236:239], v5, s[12:15], s56 offen offset:128 nt
    s_add_u32 s56, s56, 32768
    s_waitcnt vmcnt(12)
    s_mov_b64 exec, s[62:63]
    v_swap_b32 v176, v180
    v_swap_b32 v177, v181
    v_swap_b32 v178, v182
    v_swap_b32 v179, v183
    v_swap_b32 v184, v188
    v_swap_b32 v185, v189
    v_swap_b32 v186, v190
    v_swap_b32 v187, v191
    s_mov_b64 exec, -1
    s_nop 1
    v_mfma_f32_16x16x32_bf16 v[100:103], v[176:179], v[16:19], 0
    v_mfma_f32_16x16x32_bf16 v[100:103], v[184:187], v[24:27], v[100:103]
    v_mfma_f32_16x16x32_bf16 v[248:251], v[180:183], v[20:23], 0
    v_mfma_f32_16x16x32_bf16 v[248:251], v[188:191], v[28:31], v[248:251]
    v_mfma_f32_16x16x32_bf16 v[108:111], v[176:179], v[32:35], 0
    v_mfma_f32_16x16x32_bf16 v[108:111], v[184:187], v[40:43], v[108:111]
    v_mfma_f32_16x16x32_bf16 v[252:255], v[180:183], v[36:39], 0
    v_mfma_f32_16x16x32_bf16 v[252:255], v[188:191], v[44:47], v[252:255]
    v_add_f32 v96, v96, v241
    v_add_f32 v97, v97, v240
    v_add_f32 v98, v98, v243
    v_add_f32 v99, v99, v242
    v_add_f32 v104, v104, v245
    v_add_f32 v105, v105, v244
    v_add_f32 v106, v106, v247
    v_add_f32 v107, v107, v246
    buffer_load_dwordx4 v[176:179], v1, s[12:15], s56 offen offset:0 nt
    buffer_load_dwordx4 v[180:183], v5, s[12:15], s56 offen offset:0 nt
    buffer_load_dwordx4 v[184:187], v1, s[12:15], s56 offen offset:128 nt
    buffer_load_dwordx4 v[188:191], v5, s[12:15], s56 offen offset:128 nt
    s_add_u32 s56, s56, 32768
    s_waitcnt vmcnt(12)
    s_mov_b64 exec, s[62:63]
    v_swap_b32 v192, v196
    v_swap_b32 v193, v197
    v_swap_b32 v194, v198
    v_swap_b32 v195, v199
    v_swap_b32 v200, v204
    v_swap_b32 v201, v205
    v_swap_b32 v202, v206
    v_swap_b32 v203, v207
    s_mov_b64 exec, -1
    s_nop 1
    v_mfma_f32_16x16x32_bf16 v[112:115], v[192:195], v[16:19], 0
    v_mfma_f32_16x16x32_bf16 v[112:115], v[200:203], v[24:27], v[112:115]
    v_mfma_f32_16x16x32_bf16 v[240:243], v[196:199], v[20:23], 0
    v_mfma_f32_16x16x32_bf16 v[240:243], v[204:207], v[28:31], v[240:243]
    v_mfma_f32_16x16x32_bf16 v[120:123], v[192:195], v[32:35], 0
    v_mfma_f32_16x16x32_bf16 v[120:123], v[200:203], v[40:43], v[120:123]
    v_mfma_f32_16x16x32_bf16 v[244:247], v[196:199], v[36:39], 0
    v_mfma_f32_16x16x32_bf16 v[244:247], v[204:207], v[44:47], v[244:247]
    v_add_f32 v100, v100, v249
    v_add_f32 v101, v101, v248
    v_add_f32 v102, v102, v251
    v_add_f32 v103, v103, v250
    v_add_f32 v108, v108, v253
    v_add_f32 v109, v109, v252
    v_add_f32 v110, v110, v255
    v_add_f32 v111, v111, v254
    buffer_load_dwordx4 v[192:195], v1, s[12:15], s56 offen offset:0 nt
    buffer_load_dwordx4 v[196:199], v5, s[12:15], s56 offen offset:0 nt
    buffer_load_dwordx4 v[200:203], v1, s[12:15], s56 offen offset:128 nt
    buffer_load_dwordx4 v[204:207], v5, s[12:15], s56 offen offset:128 nt
    s_add_u32 s56, s56, 32768
    s_waitcnt vmcnt(12)
    s_mov_b64 exec, s[62:63]
    v_swap_b32 v208, v212
    v_swap_b32 v209, v213
    v_swap_b32 v210, v214
    v_swap_b32 v211, v215
    v_swap_b32 v216, v220
    v_swap_b32 v217, v221
    v_swap_b32 v218, v222
    v_swap_b32 v219, v223
    s_mov_b64 exec, -1
    s_nop 1
    v_mfma_f32_16x16x32_bf16 v[116:119], v[208:211], v[16:19], 0
    v_mfma_f32_16x16x32_bf16 v[116:119], v[216:219], v[24:27], v[116:119]
    v_mfma_f32_16x16x32_bf16 v[248:251], v[212:215], v[20:23], 0
    v_mfma_f32_16x16x32_bf16 v[248:251], v[220:223], v[28:31], v[248:251]
    v_mfma_f32_16x16x32_bf16 v[124:127], v[208:211], v[32:35], 0
    v_mfma_f32_16x16x32_bf16 v[124:127], v[216:219], v[40:43], v[124:127]
    v_mfma_f32_16x16x32_bf16 v[252:255], v[212:215], v[36:39], 0
    v_mfma_f32_16x16x32_bf16 v[252:255], v[220:223], v[44:47], v[252:255]
    v_add_f32 v112, v112, v241
    v_add_f32 v113, v113, v240
    v_add_f32 v114, v114, v243
    v_add_f32 v115, v115, v242
    v_add_f32 v120, v120, v245
    v_add_f32 v121, v121, v244
    v_add_f32 v122, v122, v247
    v_add_f32 v123, v123, v246
    buffer_load_dwordx4 v[208:211], v1, s[12:15], s56 offen offset:0 nt
    buffer_load_dwordx4 v[212:215], v5, s[12:15], s56 offen offset:0 nt
    buffer_load_dwordx4 v[216:219], v1, s[12:15], s56 offen offset:128 nt
    buffer_load_dwordx4 v[220:223], v5, s[12:15], s56 offen offset:128 nt
    s_add_u32 s56, s56, 32768
    s_waitcnt vmcnt(12)
    s_mov_b64 exec, s[62:63]
    v_swap_b32 v224, v228
    v_swap_b32 v225, v229
    v_swap_b32 v226, v230
    v_swap_b32 v227, v231
    v_swap_b32 v232, v236
    v_swap_b32 v233, v237
    v_swap_b32 v234, v238
    v_swap_b32 v235, v239
    s_mov_b64 exec, -1
    s_nop 1
    v_mfma_f32_16x16x32_bf16 v[128:131], v[224:227], v[16:19], 0
    v_mfma_f32_16x16x32_bf16 v[128:131], v[232:235], v[24:27], v[128:131]
    v_mfma_f32_16x16x32_bf16 v[240:243], v[228:231], v[20:23], 0
    v_mfma_f32_16x16x32_bf16 v[240:243], v[236:239], v[28:31], v[240:243]
    v_mfma_f32_16x16x32_bf16 v[136:139], v[224:227], v[32:35], 0
    v_mfma_f32_16x16x32_bf16 v[136:139], v[232:235], v[40:43], v[136:139]
    v_mfma_f32_16x16x32_bf16 v[244:247], v[228:231], v[36:39], 0
    v_mfma_f32_16x16x32_bf16 v[244:247], v[236:239], v[44:47], v[244:247]
    v_add_f32 v116, v116, v249
    v_add_f32 v117, v117, v248
    v_add_f32 v118, v118, v251
    v_add_f32 v119, v119, v250
    v_add_f32 v124, v124, v253
    v_add_f32 v125, v125, v252
    v_add_f32 v126, v126, v255
    v_add_f32 v127, v127, v254
    buffer_load_dwordx4 v[224:227], v1, s[12:15], s56 offen offset:0 nt
    buffer_load_dwordx4 v[228:231], v5, s[12:15], s56 offen offset:0 nt
    buffer_load_dwordx4 v[232:235], v1, s[12:15], s56 offen offset:128 nt
    buffer_load_dwordx4 v[236:239], v5, s[12:15], s56 offen offset:128 nt
    s_add_u32 s56, s56, 32768
    s_waitcnt vmcnt(12)
    s_mov_b64 exec, s[62:63]
    v_swap_b32 v176, v180
    v_swap_b32 v177, v181
    v_swap_b32 v178, v182
    v_swap_b32 v179, v183
    v_swap_b32 v184, v188
    v_swap_b32 v185, v189
    v_swap_b32 v186, v190
    v_swap_b32 v187, v191
    s_mov_b64 exec, -1
    s_nop 1
    v_mfma_f32_16x16x32_bf16 v[132:135], v[176:179], v[16:19], 0
    v_mfma_f32_16x16x32_bf16 v[132:135], v[184:187], v[24:27], v[132:135]
    v_mfma_f32_16x16x32_bf16 v[248:251], v[180:183], v[20:23], 0
    v_mfma_f32_16x16x32_bf16 v[248:251], v[188:191], v[28:31], v[248:251]
    v_mfma_f32_16x16x32_bf16 v[140:143], v[176:179], v[32:35], 0
    v_mfma_f32_16x16x32_bf16 v[140:143], v[184:187], v[40:43], v[140:143]
    v_mfma_f32_16x16x32_bf16 v[252:255], v[180:183], v[36:39], 0
    v_mfma_f32_16x16x32_bf16 v[252:255], v[188:191], v[44:47], v[252:255]
    v_add_f32 v128, v128, v241
    v_add_f32 v129, v129, v240
    v_add_f32 v130, v130, v243
    v_add_f32 v131, v131, v242
    v_add_f32 v136, v136, v245
    v_add_f32 v137, v137, v244
    v_add_f32 v138, v138, v247
    v_add_f32 v139, v139, v246
    buffer_load_dwordx4 v[176:179], v1, s[12:15], s56 offen offset:0 nt
    buffer_load_dwordx4 v[180:183], v5, s[12:15], s56 offen offset:0 nt
    buffer_load_dwordx4 v[184:187], v1, s[12:15], s56 offen offset:128 nt
    buffer_load_dwordx4 v[188:191], v5, s[12:15], s56 offen offset:128 nt
    s_add_u32 s56, s56, 32768
    s_waitcnt vmcnt(12)
    s_mov_b64 exec, s[62:63]
    v_swap_b32 v192, v196
    v_swap_b32 v193, v197
    v_swap_b32 v194, v198
    v_swap_b32 v195, v199
    v_swap_b32 v200, v204
    v_swap_b32 v201, v205
    v_swap_b32 v202, v206
    v_swap_b32 v203, v207
    s_mov_b64 exec, -1
    s_nop 1
    v_mfma_f32_16x16x32_bf16 v[144:147], v[192:195], v[16:19], 0
    v_mfma_f32_16x16x32_bf16 v[144:147], v[200:203], v[24:27], v[144:147]
    v_mfma_f32_16x16x32_bf16 v[240:243], v[196:199], v[20:23], 0
    v_mfma_f32_16x16x32_bf16 v[240:243], v[204:207], v[28:31], v[240:243]
    v_mfma_f32_16x16x32_bf16 v[152:155], v[192:195], v[32:35], 0
    v_mfma_f32_16x16x32_bf16 v[152:155], v[200:203], v[40:43], v[152:155]
    v_mfma_f32_16x16x32_bf16 v[244:247], v[196:199], v[36:39], 0
    v_mfma_f32_16x16x32_bf16 v[244:247], v[204:207], v[44:47], v[244:247]
    v_add_f32 v132, v132, v249
    v_add_f32 v133, v133, v248
    v_add_f32 v134, v134, v251
    v_add_f32 v135, v135, v250
    v_add_f32 v140, v140, v253
    v_add_f32 v141, v141, v252
    v_add_f32 v142, v142, v255
    v_add_f32 v143, v143, v254
    buffer_load_dwordx4 v[192:195], v2, s[24:27], 0 offen offset:0
    buffer_load_dwordx4 v[196:199], v2, s[24:27], 0 offen offset:1024
    s_waitcnt vmcnt(10)
    s_mov_b64 exec, s[62:63]
    v_swap_b32 v208, v212
    v_swap_b32 v209, v213
    v_swap_b32 v210, v214
    v_swap_b32 v211, v215
    v_swap_b32 v216, v220
    v_swap_b32 v217, v221
    v_swap_b32 v218, v222
    v_swap_b32 v219, v223
    s_mov_b64 exec, -1
    s_nop 1
    v_mfma_f32_16x16x32_bf16 v[148:151], v[208:211], v[16:19], 0
    v_mfma_f32_16x16x32_bf16 v[148:151], v[216:219], v[24:27], v[148:151]
    v_mfma_f32_16x16x32_bf16 v[248:251], v[212:215], v[20:23], 0
    v_mfma_f32_16x16x32_bf16 v[248:251], v[220:223], v[28:31], v[248:251]
    v_mfma_f32_16x16x32_bf16 v[156:159], v[208:211], v[32:35], 0
    v_mfma_f32_16x16x32_bf16 v[156:159], v[216:219], v[40:43], v[156:159]
    v_mfma_f32_16x16x32_bf16 v[252:255], v[212:215], v[36:39], 0
    v_mfma_f32_16x16x32_bf16 v[252:255], v[220:223], v[44:47], v[252:255]
    v_add_f32 v144, v144, v241
    v_add_f32 v145, v145, v240
    v_add_f32 v146, v146, v243
    v_add_f32 v147, v147, v242
    v_add_f32 v152, v152, v245
    v_add_f32 v153, v153, v244
    v_add_f32 v154, v154, v247
    v_add_f32 v155, v155, v246
    buffer_load_dwordx4 v[208:211], v2, s[16:19], s57 offen offset:0 nt
    buffer_load_dwordx4 v[212:215], v2, s[16:19], s57 offen offset:1024 nt
    buffer_load_dwordx4 v[216:219], v2, s[16:19], s57 offen offset:2048 nt
    buffer_load_dwordx4 v[220:223], v2, s[16:19], s57 offen offset:3072 nt
    s_add_u32 s57, s57, 32768
    s_waitcnt vmcnt(10)
    s_mov_b64 exec, s[62:63]
    v_swap_b32 v224, v228
    v_swap_b32 v225, v229
    v_swap_b32 v226, v230
    v_swap_b32 v227, v231
    v_swap_b32 v232, v236
    v_swap_b32 v233, v237
    v_swap_b32 v234, v238
    v_swap_b32 v235, v239
    s_mov_b64 exec, -1
    s_nop 1
    v_mfma_f32_16x16x32_bf16 v[160:163], v[224:227], v[16:19], 0
    v_mfma_f32_16x16x32_bf16 v[160:163], v[232:235], v[24:27], v[160:163]
    v_mfma_f32_16x16x32_bf16 v[240:243], v[228:231], v[20:23], 0
    v_mfma_f32_16x16x32_bf16 v[240:243], v[236:239], v[28:31], v[240:243]
    v_mfma_f32_16x16x32_bf16 v[168:171], v[224:227], v[32:35], 0
    v_mfma_f32_16x16x32_bf16 v[168:171], v[232:235], v[40:43], v[168:171]
    v_mfma_f32_16x16x32_bf16 v[244:247], v[228:231], v[36:39], 0
    v_mfma_f32_16x16x32_bf16 v[244:247], v[236:239], v[44:47], v[244:247]
    v_add_f32 v148, v148, v249
    v_add_f32 v149, v149, v248
    v_add_f32 v150, v150, v251
    v_add_f32 v151, v151, v250
    v_add_f32 v156, v156, v253
    v_add_f32 v157, v157, v252
    v_add_f32 v158, v158, v255
    v_add_f32 v159, v159, v254
    buffer_load_dwordx4 v[224:227], v2, s[16:19], s57 offen offset:0 nt
    buffer_load_dwordx4 v[228:231], v2, s[16:19], s57 offen offset:1024 nt
    buffer_load_dwordx4 v[232:235], v2, s[16:19], s57 offen offset:2048 nt
    buffer_load_dwordx4 v[236:239], v2, s[16:19], s57 offen offset:3072 nt
    s_add_u32 s57, s57, 32768
    s_waitcnt vmcnt(10)
    s_mov_b64 exec, s[62:63]
    v_swap_b32 v176, v180
    v_swap_b32 v177, v181
    v_swap_b32 v178, v182
    v_swap_b32 v179, v183
    v_swap_b32 v184, v188
    v_swap_b32 v185, v189
    v_swap_b32 v186, v190
    v_swap_b32 v187, v191
    s_mov_b64 exec, -1
    s_nop 1
    v_mfma_f32_16x16x32_bf16 v[164:167], v[176:179], v[16:19], 0
    v_mfma_f32_16x16x32_bf16 v[164:167], v[184:187], v[24:27], v[164:167]
    v_mfma_f32_16x16x32_bf16 v[248:251], v[180:183], v[20:23], 0
    v_mfma_f32_16x16x32_bf16 v[248:251], v[188:191], v[28:31], v[248:251]
    v_mfma_f32_16x16x32_bf16 v[172:175], v[176:179], v[32:35], 0
    v_mfma_f32_16x16x32_bf16 v[172:175], v[184:187], v[40:43], v[172:175]
    v_mfma_f32_16x16x32_bf16 v[252:255], v[180:183], v[36:39], 0
    v_mfma_f32_16x16x32_bf16 v[252:255], v[188:191], v[44:47], v[252:255]
    v_add_f32 v160, v160, v241
    v_add_f32 v161, v161, v240
    v_add_f32 v162, v162, v243
    v_add_f32 v163, v163, v242
    v_add_f32 v168, v168, v245
    v_add_f32 v169, v169, v244
    v_add_f32 v170, v170, v247
    v_add_f32 v171, v171, v246
    buffer_load_dwordx4 v[176:179], v2, s[16:19], s57 offen offset:0 nt
    buffer_load_dwordx4 v[180:183], v2, s[16:19], s57 offen offset:1024 nt
    buffer_load_dwordx4 v[184:187], v2, s[16:19], s57 offen offset:2048 nt
    buffer_load_dwordx4 v[188:191], v2, s[16:19], s57 offen offset:3072 nt
    s_add_u32 s57, s57, 32768
    buffer_load_dwordx4 v[16:19], v2, s[16:19], s57 offen offset:0 nt
    buffer_load_dwordx4 v[20:23], v2, s[16:19], s57 offen offset:1024 nt
    buffer_load_dwordx4 v[24:27], v2, s[16:19], s57 offen offset:2048 nt
    buffer_load_dwordx4 v[28:31], v2, s[16:19], s57 offen offset:3072 nt
    s_add_u32 s57, s57, 32768
    s_nop 7
    v_add_f32 v164, v164, v249
    v_add_f32 v165, v165, v248
    v_add_f32 v166, v166, v251
    v_add_f32 v167, v167, v250
    v_add_f32 v172, v172, v253
    v_add_f32 v173, v173, v252
    v_add_f32 v174, v174, v255
    v_add_f32 v175, v175, v254
    buffer_load_dwordx4 v[240:243], v2, s[16:19], s57 offen offset:0 nt
    buffer_load_dwordx4 v[244:247], v2, s[16:19], s57 offen offset:1024 nt
    buffer_load_dwordx4 v[248:251], v2, s[16:19], s57 offen offset:2048 nt
    buffer_load_dwordx4 v[252:255], v2, s[16:19], s57 offen offset:3072 nt
    s_add_u32 s57, s57, 32768
    v_max_f32 v10, v48, v49
    v_max3_f32 v10, v10, v50, v51
    v_max3_f32 v10, v10, v52, v53
    v_max3_f32 v10, v10, v54, v55
    v_max3_f32 v10, v10, v64, v65
    v_max3_f32 v10, v10, v66, v67
    v_max3_f32 v10, v10, v68, v69
    v_max3_f32 v10, v10, v70, v71
    v_max3_f32 v10, v10, v80, v81
    v_max3_f32 v10, v10, v82, v83
    v_max3_f32 v10, v10, v84, v85
    v_max3_f32 v10, v10, v86, v87
    v_max3_f32 v10, v10, v96, v97
    v_max3_f32 v10, v10, v98, v99
    v_max3_f32 v10, v10, v100, v101
    v_max3_f32 v10, v10, v102, v103
    v_max3_f32 v10, v10, v112, v113
    v_max3_f32 v10, v10, v114, v115
    v_max3_f32 v10, v10, v116, v117
    v_max3_f32 v10, v10, v118, v119
    v_max3_f32 v10, v10, v128, v129
    v_max3_f32 v10, v10, v130, v131
    v_max3_f32 v10, v10, v132, v133
    v_max3_f32 v10, v10, v134, v135
    v_max3_f32 v10, v10, v144, v145
    v_max3_f32 v10, v10, v146, v147
    v_max3_f32 v10, v10, v148, v149
    v_max3_f32 v10, v10, v150, v151
    v_max3_f32 v10, v10, v160, v161
    v_max3_f32 v10, v10, v162, v163
    v_max3_f32 v10, v10, v164, v165
    v_max3_f32 v10, v10, v166, v167
    v_max3_f32 v10, v10, v6, v7
    v_max_f32 v12, v56, v57
    v_max3_f32 v12, v12, v58, v59
    v_max3_f32 v12, v12, v60, v61
    v_max3_f32 v12, v12, v62, v63
    v_max3_f32 v12, v12, v72, v73
    v_max3_f32 v12, v12, v74, v75
    v_max3_f32 v12, v12, v76, v77
    v_max3_f32 v12, v12, v78, v79
    v_max3_f32 v12, v12, v88, v89
    v_max3_f32 v12, v12, v90, v91
    v_max3_f32 v12, v12, v92, v93
    v_max3_f32 v12, v12, v94, v95
    v_max3_f32 v12, v12, v104, v105
    v_max3_f32 v12, v12, v106, v107
    v_max3_f32 v12, v12, v108, v109
    v_max3_f32 v12, v12, v110, v111
    v_max3_f32 v12, v12, v120, v121
    v_max3_f32 v12, v12, v122, v123
    v_max3_f32 v12, v12, v124, v125
    v_max3_f32 v12, v12, v126, v127
    v_max3_f32 v12, v12, v136, v137
    v_max3_f32 v12, v12, v138, v139
    v_max3_f32 v12, v12, v140, v141
    v_max3_f32 v12, v12, v142, v143
    v_max3_f32 v12, v12, v152, v153
    v_max3_f32 v12, v12, v154, v155
    v_max3_f32 v12, v12, v156, v157
    v_max3_f32 v12, v12, v158, v159
    v_max3_f32 v12, v12, v168, v169
    v_max3_f32 v12, v12, v170, v171
    v_max3_f32 v12, v12, v172, v173
    v_max3_f32 v12, v12, v174, v175
    v_max3_f32 v12, v12, v8, v9
    v_mov_b32 v14, v10
    v_mov_b32 v15, v12
    s_nop 1
    v_permlane16_swap_b32 v10, v14
    v_permlane16_swap_b32 v12, v15
    s_nop 1
    v_max_f32 v10, v10, v14
    v_max_f32 v12, v12, v15
    v_mov_b32 v14, v10
    v_mov_b32 v15, v12
    s_nop 1
    v_permlane32_swap_b32 v10, v14
    v_permlane32_swap_b32 v12, v15
    s_nop 1
    v_max_f32 v10, v10, v14
    v_max_f32 v12, v12, v15
    v_mul_f32 v32, s52, v10
    v_mov_b32 v11, 0
    v_mul_f32 v33, s52, v12
    v_mov_b32 v13, 0
    v_fma_f32 v6, v6, s52, -v32
    v_fma_f32 v7, v7, s52, -v32
    v_fma_f32 v8, v8, s52, -v33
    v_fma_f32 v9, v9, s52, -v33
    v_exp_f32 v6, v6
    v_exp_f32 v7, v7
    v_exp_f32 v8, v8
    v_exp_f32 v9, v9
    s_nop 0
    v_add_f32 v34, v6, v7
    v_add_f32 v35, v8, v9
    v_cvt_pk_bf16_f32 v6, v6, v7
    v_mov_b32 v7, 0
    v_cvt_pk_bf16_f32 v8, v8, v9
    v_mov_b32 v9, 0
    v_fma_f32 v48, v48, s52, -v32
    v_fma_f32 v49, v49, s52, -v32
    v_fma_f32 v50, v50, s52, -v32
    v_fma_f32 v51, v51, s52, -v32
    v_fma_f32 v52, v52, s52, -v32
    v_fma_f32 v53, v53, s52, -v32
    v_fma_f32 v54, v54, s52, -v32
    v_fma_f32 v55, v55, s52, -v32
    v_exp_f32 v48, v48
    v_exp_f32 v49, v49
    v_exp_f32 v50, v50
    v_exp_f32 v51, v51
    v_exp_f32 v52, v52
    v_exp_f32 v53, v53
    v_exp_f32 v54, v54
    v_exp_f32 v55, v55
    v_add_f32 v11, v11, v48
    v_add_f32 v34, v34, v49
    v_add_f32 v11, v11, v50
    v_add_f32 v34, v34, v51
    v_add_f32 v11, v11, v52
    v_add_f32 v34, v34, v53
    v_add_f32 v11, v11, v54
    v_add_f32 v34, v34, v55
    v_cvt_pk_bf16_f32 v48, v48, v49
    v_cvt_pk_bf16_f32 v49, v50, v51
    v_cvt_pk_bf16_f32 v50, v52, v53
    v_cvt_pk_bf16_f32 v51, v54, v55
    v_fma_f32 v56, v56, s52, -v33
    v_fma_f32 v57, v57, s52, -v33
    v_fma_f32 v58, v58, s52, -v33
    v_fma_f32 v59, v59, s52, -v33
    v_fma_f32 v60, v60, s52, -v33
    v_fma_f32 v61, v61, s52, -v33
    v_fma_f32 v62, v62, s52, -v33
    v_fma_f32 v63, v63, s52, -v33
    v_exp_f32 v56, v56
    v_exp_f32 v57, v57
    v_exp_f32 v58, v58
    v_exp_f32 v59, v59
    v_exp_f32 v60, v60
    v_exp_f32 v61, v61
    v_exp_f32 v62, v62
    v_exp_f32 v63, v63
    v_add_f32 v13, v13, v56
    v_add_f32 v35, v35, v57
    v_add_f32 v13, v13, v58
    v_add_f32 v35, v35, v59
    v_add_f32 v13, v13, v60
    v_add_f32 v35, v35, v61
    v_add_f32 v13, v13, v62
    v_add_f32 v35, v35, v63
    v_cvt_pk_bf16_f32 v52, v56, v57
    v_cvt_pk_bf16_f32 v53, v58, v59
    v_cvt_pk_bf16_f32 v54, v60, v61
    v_cvt_pk_bf16_f32 v55, v62, v63
    v_fma_f32 v64, v64, s52, -v32
    v_fma_f32 v65, v65, s52, -v32
    v_fma_f32 v66, v66, s52, -v32
    v_fma_f32 v67, v67, s52, -v32
    v_fma_f32 v68, v68, s52, -v32
    v_fma_f32 v69, v69, s52, -v32
    v_fma_f32 v70, v70, s52, -v32
    v_fma_f32 v71, v71, s52, -v32
    v_exp_f32 v64, v64
    v_exp_f32 v65, v65
    v_exp_f32 v66, v66
    v_exp_f32 v67, v67
    v_exp_f32 v68, v68
    v_exp_f32 v69, v69
    v_exp_f32 v70, v70
    v_exp_f32 v71, v71
    v_add_f32 v11, v11, v64
    v_add_f32 v34, v34, v65
    v_add_f32 v11, v11, v66
    v_add_f32 v34, v34, v67
    v_add_f32 v11, v11, v68
    v_add_f32 v34, v34, v69
    v_add_f32 v11, v11, v70
    v_add_f32 v34, v34, v71
    v_cvt_pk_bf16_f32 v56, v64, v65
    v_cvt_pk_bf16_f32 v57, v66, v67
    v_cvt_pk_bf16_f32 v58, v68, v69
    v_cvt_pk_bf16_f32 v59, v70, v71
    v_fma_f32 v72, v72, s52, -v33
    v_fma_f32 v73, v73, s52, -v33
    v_fma_f32 v74, v74, s52, -v33
    v_fma_f32 v75, v75, s52, -v33
    v_fma_f32 v76, v76, s52, -v33
    v_fma_f32 v77, v77, s52, -v33
    v_fma_f32 v78, v78, s52, -v33
    v_fma_f32 v79, v79, s52, -v33
    v_exp_f32 v72, v72
    v_exp_f32 v73, v73
    v_exp_f32 v74, v74
    v_exp_f32 v75, v75
    v_exp_f32 v76, v76
    v_exp_f32 v77, v77
    v_exp_f32 v78, v78
    v_exp_f32 v79, v79
    v_add_f32 v13, v13, v72
    v_add_f32 v35, v35, v73
    v_add_f32 v13, v13, v74
    v_add_f32 v35, v35, v75
    v_add_f32 v13, v13, v76
    v_add_f32 v35, v35, v77
    v_add_f32 v13, v13, v78
    v_add_f32 v35, v35, v79
    v_cvt_pk_bf16_f32 v60, v72, v73
    v_cvt_pk_bf16_f32 v61, v74, v75
    v_cvt_pk_bf16_f32 v62, v76, v77
    v_cvt_pk_bf16_f32 v63, v78, v79
    v_fma_f32 v80, v80, s52, -v32
    v_fma_f32 v81, v81, s52, -v32
    v_fma_f32 v82, v82, s52, -v32
    v_fma_f32 v83, v83, s52, -v32
    v_fma_f32 v84, v84, s52, -v32
    v_fma_f32 v85, v85, s52, -v32
    v_fma_f32 v86, v86, s52, -v32
    v_fma_f32 v87, v87, s52, -v32
    v_exp_f32 v80, v80
    v_exp_f32 v81, v81
    v_exp_f32 v82, v82
    v_exp_f32 v83, v83
    v_exp_f32 v84, v84
    v_exp_f32 v85, v85
    v_exp_f32 v86, v86
    v_exp_f32 v87, v87
    v_add_f32 v11, v11, v80
    v_add_f32 v34, v34, v81
    v_add_f32 v11, v11, v82
    v_add_f32 v34, v34, v83
    v_add_f32 v11, v11, v84
    v_add_f32 v34, v34, v85
    v_add_f32 v11, v11, v86
    v_add_f32 v34, v34, v87
    v_cvt_pk_bf16_f32 v64, v80, v81
    v_cvt_pk_bf16_f32 v65, v82, v83
    v_cvt_pk_bf16_f32 v66, v84, v85
    v_cvt_pk_bf16_f32 v67, v86, v87
    v_fma_f32 v88, v88, s52, -v33
    v_fma_f32 v89, v89, s52, -v33
    v_fma_f32 v90, v90, s52, -v33
    v_fma_f32 v91, v91, s52, -v33
    v_fma_f32 v92, v92, s52, -v33
    v_fma_f32 v93, v93, s52, -v33
    v_fma_f32 v94, v94, s52, -v33
    v_fma_f32 v95, v95, s52, -v33
    v_exp_f32 v88, v88
    v_exp_f32 v89, v89
    v_exp_f32 v90, v90
    v_exp_f32 v91, v91
    v_exp_f32 v92, v92
    v_exp_f32 v93, v93
    v_exp_f32 v94, v94
    v_exp_f32 v95, v95
    v_add_f32 v13, v13, v88
    v_add_f32 v35, v35, v89
    v_add_f32 v13, v13, v90
    v_add_f32 v35, v35, v91
    v_add_f32 v13, v13, v92
    v_add_f32 v35, v35, v93
    v_add_f32 v13, v13, v94
    v_add_f32 v35, v35, v95
    v_cvt_pk_bf16_f32 v68, v88, v89
    v_cvt_pk_bf16_f32 v69, v90, v91
    v_cvt_pk_bf16_f32 v70, v92, v93
    v_cvt_pk_bf16_f32 v71, v94, v95
    v_fma_f32 v96, v96, s52, -v32
    v_fma_f32 v97, v97, s52, -v32
    v_fma_f32 v98, v98, s52, -v32
    v_fma_f32 v99, v99, s52, -v32
    v_fma_f32 v100, v100, s52, -v32
    v_fma_f32 v101, v101, s52, -v32
    v_fma_f32 v102, v102, s52, -v32
    v_fma_f32 v103, v103, s52, -v32
    v_exp_f32 v96, v96
    v_exp_f32 v97, v97
    v_exp_f32 v98, v98
    v_exp_f32 v99, v99
    v_exp_f32 v100, v100
    v_exp_f32 v101, v101
    v_exp_f32 v102, v102
    v_exp_f32 v103, v103
    v_add_f32 v11, v11, v96
    v_add_f32 v34, v34, v97
    v_add_f32 v11, v11, v98
    v_add_f32 v34, v34, v99
    v_add_f32 v11, v11, v100
    v_add_f32 v34, v34, v101
    v_add_f32 v11, v11, v102
    v_add_f32 v34, v34, v103
    v_cvt_pk_bf16_f32 v72, v96, v97
    v_cvt_pk_bf16_f32 v73, v98, v99
    v_cvt_pk_bf16_f32 v74, v100, v101
    v_cvt_pk_bf16_f32 v75, v102, v103
    v_fma_f32 v104, v104, s52, -v33
    v_fma_f32 v105, v105, s52, -v33
    v_fma_f32 v106, v106, s52, -v33
    v_fma_f32 v107, v107, s52, -v33
    v_fma_f32 v108, v108, s52, -v33
    v_fma_f32 v109, v109, s52, -v33
    v_fma_f32 v110, v110, s52, -v33
    v_fma_f32 v111, v111, s52, -v33
    v_exp_f32 v104, v104
    v_exp_f32 v105, v105
    v_exp_f32 v106, v106
    v_exp_f32 v107, v107
    v_exp_f32 v108, v108
    v_exp_f32 v109, v109
    v_exp_f32 v110, v110
    v_exp_f32 v111, v111
    v_add_f32 v13, v13, v104
    v_add_f32 v35, v35, v105
    v_add_f32 v13, v13, v106
    v_add_f32 v35, v35, v107
    v_add_f32 v13, v13, v108
    v_add_f32 v35, v35, v109
    v_add_f32 v13, v13, v110
    v_add_f32 v35, v35, v111
    v_cvt_pk_bf16_f32 v76, v104, v105
    v_cvt_pk_bf16_f32 v77, v106, v107
    v_cvt_pk_bf16_f32 v78, v108, v109
    v_cvt_pk_bf16_f32 v79, v110, v111
    v_fma_f32 v112, v112, s52, -v32
    v_fma_f32 v113, v113, s52, -v32
    v_fma_f32 v114, v114, s52, -v32
    v_fma_f32 v115, v115, s52, -v32
    v_fma_f32 v116, v116, s52, -v32
    v_fma_f32 v117, v117, s52, -v32
    v_fma_f32 v118, v118, s52, -v32
    v_fma_f32 v119, v119, s52, -v32
    v_exp_f32 v112, v112
    v_exp_f32 v113, v113
    v_exp_f32 v114, v114
    v_exp_f32 v115, v115
    v_exp_f32 v116, v116
    v_exp_f32 v117, v117
    v_exp_f32 v118, v118
    v_exp_f32 v119, v119
    v_add_f32 v11, v11, v112
    v_add_f32 v34, v34, v113
    v_add_f32 v11, v11, v114
    v_add_f32 v34, v34, v115
    v_add_f32 v11, v11, v116
    v_add_f32 v34, v34, v117
    v_add_f32 v11, v11, v118
    v_add_f32 v34, v34, v119
    v_cvt_pk_bf16_f32 v80, v112, v113
    v_cvt_pk_bf16_f32 v81, v114, v115
    v_cvt_pk_bf16_f32 v82, v116, v117
    v_cvt_pk_bf16_f32 v83, v118, v119
    v_fma_f32 v120, v120, s52, -v33
    v_fma_f32 v121, v121, s52, -v33
    v_fma_f32 v122, v122, s52, -v33
    v_fma_f32 v123, v123, s52, -v33
    v_fma_f32 v124, v124, s52, -v33
    v_fma_f32 v125, v125, s52, -v33
    v_fma_f32 v126, v126, s52, -v33
    v_fma_f32 v127, v127, s52, -v33
    v_exp_f32 v120, v120
    v_exp_f32 v121, v121
    v_exp_f32 v122, v122
    v_exp_f32 v123, v123
    v_exp_f32 v124, v124
    v_exp_f32 v125, v125
    v_exp_f32 v126, v126
    v_exp_f32 v127, v127
    v_add_f32 v13, v13, v120
    v_add_f32 v35, v35, v121
    v_add_f32 v13, v13, v122
    v_add_f32 v35, v35, v123
    v_add_f32 v13, v13, v124
    v_add_f32 v35, v35, v125
    v_add_f32 v13, v13, v126
    v_add_f32 v35, v35, v127
    v_cvt_pk_bf16_f32 v84, v120, v121
    v_cvt_pk_bf16_f32 v85, v122, v123
    v_cvt_pk_bf16_f32 v86, v124, v125
    v_cvt_pk_bf16_f32 v87, v126, v127
    v_fma_f32 v128, v128, s52, -v32
    v_fma_f32 v129, v129, s52, -v32
    v_fma_f32 v130, v130, s52, -v32
    v_fma_f32 v131, v131, s52, -v32
    v_fma_f32 v132, v132, s52, -v32
    v_fma_f32 v133, v133, s52, -v32
    v_fma_f32 v134, v134, s52, -v32
    v_fma_f32 v135, v135, s52, -v32
    v_exp_f32 v128, v128
    v_exp_f32 v129, v129
    v_exp_f32 v130, v130
    v_exp_f32 v131, v131
    v_exp_f32 v132, v132
    v_exp_f32 v133, v133
    v_exp_f32 v134, v134
    v_exp_f32 v135, v135
    v_add_f32 v11, v11, v128
    v_add_f32 v34, v34, v129
    v_add_f32 v11, v11, v130
    v_add_f32 v34, v34, v131
    v_add_f32 v11, v11, v132
    v_add_f32 v34, v34, v133
    v_add_f32 v11, v11, v134
    v_add_f32 v34, v34, v135
    v_cvt_pk_bf16_f32 v88, v128, v129
    v_cvt_pk_bf16_f32 v89, v130, v131
    v_cvt_pk_bf16_f32 v90, v132, v133
    v_cvt_pk_bf16_f32 v91, v134, v135
    v_fma_f32 v136, v136, s52, -v33
    v_fma_f32 v137, v137, s52, -v33
    v_fma_f32 v138, v138, s52, -v33
    v_fma_f32 v139, v139, s52, -v33
    v_fma_f32 v140, v140, s52, -v33
    v_fma_f32 v141, v141, s52, -v33
    v_fma_f32 v142, v142, s52, -v33
    v_fma_f32 v143, v143, s52, -v33
    v_exp_f32 v136, v136
    v_exp_f32 v137, v137
    v_exp_f32 v138, v138
    v_exp_f32 v139, v139
    v_exp_f32 v140, v140
    v_exp_f32 v141, v141
    v_exp_f32 v142, v142
    v_exp_f32 v143, v143
    v_add_f32 v13, v13, v136
    v_add_f32 v35, v35, v137
    v_add_f32 v13, v13, v138
    v_add_f32 v35, v35, v139
    v_add_f32 v13, v13, v140
    v_add_f32 v35, v35, v141
    v_add_f32 v13, v13, v142
    v_add_f32 v35, v35, v143
    v_cvt_pk_bf16_f32 v92, v136, v137
    v_cvt_pk_bf16_f32 v93, v138, v139
    v_cvt_pk_bf16_f32 v94, v140, v141
    v_cvt_pk_bf16_f32 v95, v142, v143
    v_fma_f32 v144, v144, s52, -v32
    v_fma_f32 v145, v145, s52, -v32
    v_fma_f32 v146, v146, s52, -v32
    v_fma_f32 v147, v147, s52, -v32
    v_fma_f32 v148, v148, s52, -v32
    v_fma_f32 v149, v149, s52, -v32
    v_fma_f32 v150, v150, s52, -v32
    v_fma_f32 v151, v151, s52, -v32
    v_exp_f32 v144, v144
    v_exp_f32 v145, v145
    v_exp_f32 v146, v146
    v_exp_f32 v147, v147
    v_exp_f32 v148, v148
    v_exp_f32 v149, v149
    v_exp_f32 v150, v150
    v_exp_f32 v151, v151
    v_add_f32 v11, v11, v144
    v_add_f32 v34, v34, v145
    v_add_f32 v11, v11, v146
    v_add_f32 v34, v34, v147
    v_add_f32 v11, v11, v148
    v_add_f32 v34, v34, v149
    v_add_f32 v11, v11, v150
    v_add_f32 v34, v34, v151
    v_cvt_pk_bf16_f32 v96, v144, v145
    v_cvt_pk_bf16_f32 v97, v146, v147
    v_cvt_pk_bf16_f32 v98, v148, v149
    v_cvt_pk_bf16_f32 v99, v150, v151
    v_fma_f32 v152, v152, s52, -v33
    v_fma_f32 v153, v153, s52, -v33
    v_fma_f32 v154, v154, s52, -v33
    v_fma_f32 v155, v155, s52, -v33
    v_fma_f32 v156, v156, s52, -v33
    v_fma_f32 v157, v157, s52, -v33
    v_fma_f32 v158, v158, s52, -v33
    v_fma_f32 v159, v159, s52, -v33
    v_exp_f32 v152, v152
    v_exp_f32 v153, v153
    v_exp_f32 v154, v154
    v_exp_f32 v155, v155
    v_exp_f32 v156, v156
    v_exp_f32 v157, v157
    v_exp_f32 v158, v158
    v_exp_f32 v159, v159
    v_add_f32 v13, v13, v152
    v_add_f32 v35, v35, v153
    v_add_f32 v13, v13, v154
    v_add_f32 v35, v35, v155
    v_add_f32 v13, v13, v156
    v_add_f32 v35, v35, v157
    v_add_f32 v13, v13, v158
    v_add_f32 v35, v35, v159
    v_cvt_pk_bf16_f32 v100, v152, v153
    v_cvt_pk_bf16_f32 v101, v154, v155
    v_cvt_pk_bf16_f32 v102, v156, v157
    v_cvt_pk_bf16_f32 v103, v158, v159
    v_fma_f32 v160, v160, s52, -v32
    v_fma_f32 v161, v161, s52, -v32
    v_fma_f32 v162, v162, s52, -v32
    v_fma_f32 v163, v163, s52, -v32
    v_fma_f32 v164, v164, s52, -v32
    v_fma_f32 v165, v165, s52, -v32
    v_fma_f32 v166, v166, s52, -v32
    v_fma_f32 v167, v167, s52, -v32
    v_exp_f32 v160, v160
    v_exp_f32 v161, v161
    v_exp_f32 v162, v162
    v_exp_f32 v163, v163
    v_exp_f32 v164, v164
    v_exp_f32 v165, v165
    v_exp_f32 v166, v166
    v_exp_f32 v167, v167
    v_add_f32 v11, v11, v160
    v_add_f32 v34, v34, v161
    v_add_f32 v11, v11, v162
    v_add_f32 v34, v34, v163
    v_add_f32 v11, v11, v164
    v_add_f32 v34, v34, v165
    v_add_f32 v11, v11, v166
    v_add_f32 v34, v34, v167
    v_cvt_pk_bf16_f32 v104, v160, v161
    v_cvt_pk_bf16_f32 v105, v162, v163
    v_cvt_pk_bf16_f32 v106, v164, v165
    v_cvt_pk_bf16_f32 v107, v166, v167
    v_fma_f32 v168, v168, s52, -v33
    v_fma_f32 v169, v169, s52, -v33
    v_fma_f32 v170, v170, s52, -v33
    v_fma_f32 v171, v171, s52, -v33
    v_fma_f32 v172, v172, s52, -v33
    v_fma_f32 v173, v173, s52, -v33
    v_fma_f32 v174, v174, s52, -v33
    v_fma_f32 v175, v175, s52, -v33
    v_exp_f32 v168, v168
    v_exp_f32 v169, v169
    v_exp_f32 v170, v170
    v_exp_f32 v171, v171
    v_exp_f32 v172, v172
    v_exp_f32 v173, v173
    v_exp_f32 v174, v174
    v_exp_f32 v175, v175
    v_add_f32 v13, v13, v168
    v_add_f32 v35, v35, v169
    v_add_f32 v13, v13, v170
    v_add_f32 v35, v35, v171
    v_add_f32 v13, v13, v172
    v_add_f32 v35, v35, v173
    v_add_f32 v13, v13, v174
    v_add_f32 v35, v35, v175
    v_cvt_pk_bf16_f32 v108, v168, v169
    v_cvt_pk_bf16_f32 v109, v170, v171
    v_cvt_pk_bf16_f32 v110, v172, v173
    v_cvt_pk_bf16_f32 v111, v174, v175
    v_add_f32 v11, v11, v34
    v_add_f32 v13, v13, v35
    v_mov_b32 v14, v11
    v_mov_b32 v15, v13
    s_nop 1
    v_permlane16_swap_b32 v11, v14
    v_permlane16_swap_b32 v13, v15
    s_nop 1
    v_add_f32 v11, v11, v14
    v_add_f32 v13, v13, v15
    v_mov_b32 v14, v11
    v_mov_b32 v15, v13
    s_nop 1
    v_permlane32_swap_b32 v11, v14
    v_permlane32_swap_b32 v13, v15
    s_nop 1
    v_add_f32 v11, v11, v14
    v_add_f32 v13, v13, v15
    v_lshrrev_b32 v32, 4, v2
    v_and_b32 v33, 15, v32
    v_lshrrev_b32 v34, 4, v32
    v_mul_u32_u24 v1, 528, v33
    v_lshl_add_u32 v1, v34, 7, v1
    s_mul_i32 s58, s3, 16896
    v_add_u32 v1, s58, v1
    s_lshl_b32 s58, s3, 8
    s_add_u32 s58, s58, 135168
    v_lshlrev_b32 v5, 3, v33
    v_add_u32 v5, s58, v5
    ds_write_b64 v5, v[10:11] offset:0
    ds_write_b64 v5, v[12:13] offset:128
    v_lshrrev_b32 v32, 4, v0
    v_and_b32 v33, 15, v0
    v_mul_u32_u24 v3, 528, v32
    v_lshl_add_u32 v3, v33, 5, v3
    v_add_u32 v4, 67584, v3
    v_lshlrev_b32 v14, 3, v32
    v_add_u32 v14, 135168, v14
    v_lshlrev_b32 v15, 8, v32
    v_lshrrev_b32 v34, 2, v33
    v_lshl_add_u32 v15, v34, 6, v15
    v_and_b32 v34, 3, v33
    v_lshl_add_u32 v15, v34, 2, v15
    s_waitcnt vmcnt(20)
    v_perm_b32 v32, v196, v192, s53
    v_mov_b32 v33, 0
    v_perm_b32 v34, v196, v192, s54
    v_mov_b32 v35, 0
    s_nop 1
    v_mfma_f32_16x16x16_bf16 v[112:115], v[32:33], v[6:7], 0
    v_mfma_f32_16x16x16_bf16 v[116:119], v[32:33], v[8:9], 0
    v_mfma_f32_16x16x16_bf16 v[120:123], v[34:35], v[6:7], 0
    v_mfma_f32_16x16x16_bf16 v[124:127], v[34:35], v[8:9], 0
    v_perm_b32 v40, v197, v193, s53
    v_mov_b32 v41, 0
    v_perm_b32 v42, v197, v193, s54
    v_mov_b32 v43, 0
    s_nop 1
    v_mfma_f32_16x16x16_bf16 v[128:131], v[40:41], v[6:7], 0
    v_mfma_f32_16x16x16_bf16 v[132:135], v[40:41], v[8:9], 0
    v_mfma_f32_16x16x16_bf16 v[136:139], v[42:43], v[6:7], 0
    v_mfma_f32_16x16x16_bf16 v[140:143], v[42:43], v[8:9], 0
    v_perm_b32 v32, v198, v194, s53
    v_mov_b32 v33, 0
    v_perm_b32 v34, v198, v194, s54
    v_mov_b32 v35, 0
    s_nop 1
    v_mfma_f32_16x16x16_bf16 v[144:147], v[32:33], v[6:7], 0
    v_mfma_f32_16x16x16_bf16 v[148:151], v[32:33], v[8:9], 0
    v_mfma_f32_16x16x16_bf16 v[152:155], v[34:35], v[6:7], 0
    v_mfma_f32_16x16x16_bf16 v[156:159], v[34:35], v[8:9], 0
    v_perm_b32 v40, v199, v195, s53
    v_mov_b32 v41, 0
    v_perm_b32 v42, v199, v195, s54
    v_mov_b32 v43, 0
    s_nop 1
    v_mfma_f32_16x16x16_bf16 v[160:163], v[40:41], v[6:7], 0
    v_mfma_f32_16x16x16_bf16 v[164:167], v[40:41], v[8:9], 0
    v_mfma_f32_16x16x16_bf16 v[168:171], v[42:43], v[6:7], 0
    v_mfma_f32_16x16x16_bf16 v[172:175], v[42:43], v[8:9], 0
    buffer_load_dwordx4 v[192:195], v2, s[16:19], s57 offen offset:0 nt
    buffer_load_dwordx4 v[196:199], v2, s[16:19], s57 offen offset:1024 nt
    buffer_load_dwordx4 v[200:203], v2, s[16:19], s57 offen offset:2048 nt
    buffer_load_dwordx4 v[204:207], v2, s[16:19], s57 offen offset:3072 nt
    s_add_u32 s57, s57, 32768
    s_waitcnt vmcnt(16)
    v_perm_b32 v32, v212, v208, s53
    v_perm_b32 v33, v220, v216, s53
    v_perm_b32 v34, v228, v224, s53
    v_perm_b32 v35, v236, v232, s53
    v_perm_b32 v36, v212, v208, s54
    v_perm_b32 v37, v220, v216, s54
    v_perm_b32 v38, v228, v224, s54
    v_perm_b32 v39, v236, v232, s54
    v_mfma_f32_16x16x32_bf16 v[112:115], v[32:35], v[48:51], v[112:115]
    v_mfma_f32_16x16x32_bf16 v[116:119], v[32:35], v[52:55], v[116:119]
    v_mfma_f32_16x16x32_bf16 v[120:123], v[36:39], v[48:51], v[120:123]
    v_mfma_f32_16x16x32_bf16 v[124:127], v[36:39], v[52:55], v[124:127]
    v_perm_b32 v40, v213, v209, s53
    v_perm_b32 v41, v221, v217, s53
    v_perm_b32 v42, v229, v225, s53
    v_perm_b32 v43, v237, v233, s53
    v_perm_b32 v44, v213, v209, s54
    v_perm_b32 v45, v221, v217, s54
    v_perm_b32 v46, v229, v225, s54
    v_perm_b32 v47, v237, v233, s54
    v_mfma_f32_16x16x32_bf16 v[128:131], v[40:43], v[48:51], v[128:131]
    v_mfma_f32_16x16x32_bf16 v[132:135], v[40:43], v[52:55], v[132:135]
    v_mfma_f32_16x16x32_bf16 v[136:139], v[44:47], v[48:51], v[136:139]
    v_mfma_f32_16x16x32_bf16 v[140:143], v[44:47], v[52:55], v[140:143]
    v_perm_b32 v32, v214, v210, s53
    v_perm_b32 v33, v222, v218, s53
    v_perm_b32 v34, v230, v226, s53
    v_perm_b32 v35, v238, v234, s53
    v_perm_b32 v36, v214, v210, s54
    v_perm_b32 v37, v222, v218, s54
    v_perm_b32 v38, v230, v226, s54
    v_perm_b32 v39, v238, v234, s54
    v_mfma_f32_16x16x32_bf16 v[144:147], v[32:35], v[48:51], v[144:147]
    v_mfma_f32_16x16x32_bf16 v[148:151], v[32:35], v[52:55], v[148:151]
    v_mfma_f32_16x16x32_bf16 v[152:155], v[36:39], v[48:51], v[152:155]
    v_mfma_f32_16x16x32_bf16 v[156:159], v[36:39], v[52:55], v[156:159]
    v_perm_b32 v40, v215, v211, s53
    v_perm_b32 v41, v223, v219, s53
    v_perm_b32 v42, v231, v227, s53
    v_perm_b32 v43, v239, v235, s53
    v_perm_b32 v44, v215, v211, s54
    v_perm_b32 v45, v223, v219, s54
    v_perm_b32 v46, v231, v227, s54
    v_perm_b32 v47, v239, v235, s54
    v_mfma_f32_16x16x32_bf16 v[160:163], v[40:43], v[48:51], v[160:163]
    v_mfma_f32_16x16x32_bf16 v[164:167], v[40:43], v[52:55], v[164:167]
    v_mfma_f32_16x16x32_bf16 v[168:171], v[44:47], v[48:51], v[168:171]
    v_mfma_f32_16x16x32_bf16 v[172:175], v[44:47], v[52:55], v[172:175]
    buffer_load_dwordx4 v[208:211], v2, s[16:19], s57 offen offset:0 nt
    buffer_load_dwordx4 v[212:215], v2, s[16:19], s57 offen offset:1024 nt
    buffer_load_dwordx4 v[216:219], v2, s[16:19], s57 offen offset:2048 nt
    buffer_load_dwordx4 v[220:223], v2, s[16:19], s57 offen offset:3072 nt
    s_add_u32 s57, s57, 32768
    buffer_load_dwordx4 v[224:227], v2, s[16:19], s57 offen offset:0 nt
    buffer_load_dwordx4 v[228:231], v2, s[16:19], s57 offen offset:1024 nt
    buffer_load_dwordx4 v[232:235], v2, s[16:19], s57 offen offset:2048 nt
    buffer_load_dwordx4 v[236:239], v2, s[16:19], s57 offen offset:3072 nt
    s_add_u32 s57, s57, 32768
    s_waitcnt vmcnt(16)
    v_perm_b32 v32, v180, v176, s53
    v_perm_b32 v33, v188, v184, s53
    v_perm_b32 v34, v20, v16, s53
    v_perm_b32 v35, v28, v24, s53
    v_perm_b32 v36, v180, v176, s54
    v_perm_b32 v37, v188, v184, s54
    v_perm_b32 v38, v20, v16, s54
    v_perm_b32 v39, v28, v24, s54
    v_mfma_f32_16x16x32_bf16 v[112:115], v[32:35], v[56:59], v[112:115]
    v_mfma_f32_16x16x32_bf16 v[116:119], v[32:35], v[60:63], v[116:119]
    v_mfma_f32_16x16x32_bf16 v[120:123], v[36:39], v[56:59], v[120:123]
    v_mfma_f32_16x16x32_bf16 v[124:127], v[36:39], v[60:63], v[124:127]
    v_perm_b32 v40, v181, v177, s53
    v_perm_b32 v41, v189, v185, s53
    v_perm_b32 v42, v21, v17, s53
    v_perm_b32 v43, v29, v25, s53
    v_perm_b32 v44, v181, v177, s54
    v_perm_b32 v45, v189, v185, s54
    v_perm_b32 v46, v21, v17, s54
    v_perm_b32 v47, v29, v25, s54
    v_mfma_f32_16x16x32_bf16 v[128:131], v[40:43], v[56:59], v[128:131]
    v_mfma_f32_16x16x32_bf16 v[132:135], v[40:43], v[60:63], v[132:135]
    v_mfma_f32_16x16x32_bf16 v[136:139], v[44:47], v[56:59], v[136:139]
    v_mfma_f32_16x16x32_bf16 v[140:143], v[44:47], v[60:63], v[140:143]
    v_perm_b32 v32, v182, v178, s53
    v_perm_b32 v33, v190, v186, s53
    v_perm_b32 v34, v22, v18, s53
    v_perm_b32 v35, v30, v26, s53
    v_perm_b32 v36, v182, v178, s54
    v_perm_b32 v37, v190, v186, s54
    v_perm_b32 v38, v22, v18, s54
    v_perm_b32 v39, v30, v26, s54
    v_mfma_f32_16x16x32_bf16 v[144:147], v[32:35], v[56:59], v[144:147]
    v_mfma_f32_16x16x32_bf16 v[148:151], v[32:35], v[60:63], v[148:151]
    v_mfma_f32_16x16x32_bf16 v[152:155], v[36:39], v[56:59], v[152:155]
    v_mfma_f32_16x16x32_bf16 v[156:159], v[36:39], v[60:63], v[156:159]
    v_perm_b32 v40, v183, v179, s53
    v_perm_b32 v41, v191, v187, s53
    v_perm_b32 v42, v23, v19, s53
    v_perm_b32 v43, v31, v27, s53
    v_perm_b32 v44, v183, v179, s54
    v_perm_b32 v45, v191, v187, s54
    v_perm_b32 v46, v23, v19, s54
    v_perm_b32 v47, v31, v27, s54
    v_mfma_f32_16x16x32_bf16 v[160:163], v[40:43], v[56:59], v[160:163]
    v_mfma_f32_16x16x32_bf16 v[164:167], v[40:43], v[60:63], v[164:167]
    v_mfma_f32_16x16x32_bf16 v[168:171], v[44:47], v[56:59], v[168:171]
    v_mfma_f32_16x16x32_bf16 v[172:175], v[44:47], v[60:63], v[172:175]
    buffer_load_dwordx4 v[176:179], v2, s[16:19], s57 offen offset:0 nt
    buffer_load_dwordx4 v[180:183], v2, s[16:19], s57 offen offset:1024 nt
    buffer_load_dwordx4 v[184:187], v2, s[16:19], s57 offen offset:2048 nt
    buffer_load_dwordx4 v[188:191], v2, s[16:19], s57 offen offset:3072 nt
    s_add_u32 s57, s57, 32768
    buffer_load_dwordx4 v[16:19], v2, s[16:19], s57 offen offset:0 nt
    buffer_load_dwordx4 v[20:23], v2, s[16:19], s57 offen offset:1024 nt
    buffer_load_dwordx4 v[24:27], v2, s[16:19], s57 offen offset:2048 nt
    buffer_load_dwordx4 v[28:31], v2, s[16:19], s57 offen offset:3072 nt
    s_add_u32 s57, s57, 32768
    buffer_load_dwordx4 v[48:51], v2, s[16:19], s57 offen offset:0 nt
    buffer_load_dwordx4 v[52:55], v2, s[16:19], s57 offen offset:1024 nt
    buffer_load_dwordx4 v[56:59], v2, s[16:19], s57 offen offset:2048 nt
    buffer_load_dwordx4 v[60:63], v2, s[16:19], s57 offen offset:3072 nt
    s_add_u32 s57, s57, 32768
    s_waitcnt vmcnt(20)
    v_perm_b32 v32, v244, v240, s53
    v_perm_b32 v33, v252, v248, s53
    v_perm_b32 v34, v196, v192, s53
    v_perm_b32 v35, v204, v200, s53
    v_perm_b32 v36, v244, v240, s54
    v_perm_b32 v37, v252, v248, s54
    v_perm_b32 v38, v196, v192, s54
    v_perm_b32 v39, v204, v200, s54
    v_mfma_f32_16x16x32_bf16 v[112:115], v[32:35], v[64:67], v[112:115]
    v_mfma_f32_16x16x32_bf16 v[116:119], v[32:35], v[68:71], v[116:119]
    v_mfma_f32_16x16x32_bf16 v[120:123], v[36:39], v[64:67], v[120:123]
    v_mfma_f32_16x16x32_bf16 v[124:127], v[36:39], v[68:71], v[124:127]
    v_perm_b32 v40, v245, v241, s53
    v_perm_b32 v41, v253, v249, s53
    v_perm_b32 v42, v197, v193, s53
    v_perm_b32 v43, v205, v201, s53
    v_perm_b32 v44, v245, v241, s54
    v_perm_b32 v45, v253, v249, s54
    v_perm_b32 v46, v197, v193, s54
    v_perm_b32 v47, v205, v201, s54
    v_mfma_f32_16x16x32_bf16 v[128:131], v[40:43], v[64:67], v[128:131]
    v_mfma_f32_16x16x32_bf16 v[132:135], v[40:43], v[68:71], v[132:135]
    v_mfma_f32_16x16x32_bf16 v[136:139], v[44:47], v[64:67], v[136:139]
    v_mfma_f32_16x16x32_bf16 v[140:143], v[44:47], v[68:71], v[140:143]
    v_perm_b32 v32, v246, v242, s53
    v_perm_b32 v33, v254, v250, s53
    v_perm_b32 v34, v198, v194, s53
    v_perm_b32 v35, v206, v202, s53
    v_perm_b32 v36, v246, v242, s54
    v_perm_b32 v37, v254, v250, s54
    v_perm_b32 v38, v198, v194, s54
    v_perm_b32 v39, v206, v202, s54
    v_mfma_f32_16x16x32_bf16 v[144:147], v[32:35], v[64:67], v[144:147]
    v_mfma_f32_16x16x32_bf16 v[148:151], v[32:35], v[68:71], v[148:151]
    v_mfma_f32_16x16x32_bf16 v[152:155], v[36:39], v[64:67], v[152:155]
    v_mfma_f32_16x16x32_bf16 v[156:159], v[36:39], v[68:71], v[156:159]
    v_perm_b32 v40, v247, v243, s53
    v_perm_b32 v41, v255, v251, s53
    v_perm_b32 v42, v199, v195, s53
    v_perm_b32 v43, v207, v203, s53
    v_perm_b32 v44, v247, v243, s54
    v_perm_b32 v45, v255, v251, s54
    v_perm_b32 v46, v199, v195, s54
    v_perm_b32 v47, v207, v203, s54
    v_mfma_f32_16x16x32_bf16 v[160:163], v[40:43], v[64:67], v[160:163]
    v_mfma_f32_16x16x32_bf16 v[164:167], v[40:43], v[68:71], v[164:167]
    v_mfma_f32_16x16x32_bf16 v[168:171], v[44:47], v[64:67], v[168:171]
    v_mfma_f32_16x16x32_bf16 v[172:175], v[44:47], v[68:71], v[172:175]
    buffer_load_dwordx4 v[240:243], v2, s[16:19], s57 offen offset:0 nt
    buffer_load_dwordx4 v[244:247], v2, s[16:19], s57 offen offset:1024 nt
    buffer_load_dwordx4 v[248:251], v2, s[16:19], s57 offen offset:2048 nt
    buffer_load_dwordx4 v[252:255], v2, s[16:19], s57 offen offset:3072 nt
    s_add_u32 s57, s57, 32768
    buffer_load_dwordx4 v[192:195], v2, s[16:19], s57 offen offset:0 nt
    buffer_load_dwordx4 v[196:199], v2, s[16:19], s57 offen offset:1024 nt
    buffer_load_dwordx4 v[200:203], v2, s[16:19], s57 offen offset:2048 nt
    buffer_load_dwordx4 v[204:207], v2, s[16:19], s57 offen offset:3072 nt
    s_add_u32 s57, s57, 32768
    s_waitcnt vmcnt(20)
    v_perm_b32 v32, v212, v208, s53
    v_perm_b32 v33, v220, v216, s53
    v_perm_b32 v34, v228, v224, s53
    v_perm_b32 v35, v236, v232, s53
    v_perm_b32 v36, v212, v208, s54
    v_perm_b32 v37, v220, v216, s54
    v_perm_b32 v38, v228, v224, s54
    v_perm_b32 v39, v236, v232, s54
    v_mfma_f32_16x16x32_bf16 v[112:115], v[32:35], v[72:75], v[112:115]
    v_mfma_f32_16x16x32_bf16 v[116:119], v[32:35], v[76:79], v[116:119]
    v_mfma_f32_16x16x32_bf16 v[120:123], v[36:39], v[72:75], v[120:123]
    v_mfma_f32_16x16x32_bf16 v[124:127], v[36:39], v[76:79], v[124:127]
    v_perm_b32 v40, v213, v209, s53
    v_perm_b32 v41, v221, v217, s53
    v_perm_b32 v42, v229, v225, s53
    v_perm_b32 v43, v237, v233, s53
    v_perm_b32 v44, v213, v209, s54
    v_perm_b32 v45, v221, v217, s54
    v_perm_b32 v46, v229, v225, s54
    v_perm_b32 v47, v237, v233, s54
    v_mfma_f32_16x16x32_bf16 v[128:131], v[40:43], v[72:75], v[128:131]
    v_mfma_f32_16x16x32_bf16 v[132:135], v[40:43], v[76:79], v[132:135]
    v_mfma_f32_16x16x32_bf16 v[136:139], v[44:47], v[72:75], v[136:139]
    v_mfma_f32_16x16x32_bf16 v[140:143], v[44:47], v[76:79], v[140:143]
    v_perm_b32 v32, v214, v210, s53
    v_perm_b32 v33, v222, v218, s53
    v_perm_b32 v34, v230, v226, s53
    v_perm_b32 v35, v238, v234, s53
    v_perm_b32 v36, v214, v210, s54
    v_perm_b32 v37, v222, v218, s54
    v_perm_b32 v38, v230, v226, s54
    v_perm_b32 v39, v238, v234, s54
    v_mfma_f32_16x16x32_bf16 v[144:147], v[32:35], v[72:75], v[144:147]
    v_mfma_f32_16x16x32_bf16 v[148:151], v[32:35], v[76:79], v[148:151]
    v_mfma_f32_16x16x32_bf16 v[152:155], v[36:39], v[72:75], v[152:155]
    v_mfma_f32_16x16x32_bf16 v[156:159], v[36:39], v[76:79], v[156:159]
    v_perm_b32 v40, v215, v211, s53
    v_perm_b32 v41, v223, v219, s53
    v_perm_b32 v42, v231, v227, s53
    v_perm_b32 v43, v239, v235, s53
    v_perm_b32 v44, v215, v211, s54
    v_perm_b32 v45, v223, v219, s54
    v_perm_b32 v46, v231, v227, s54
    v_perm_b32 v47, v239, v235, s54
    v_mfma_f32_16x16x32_bf16 v[160:163], v[40:43], v[72:75], v[160:163]
    v_mfma_f32_16x16x32_bf16 v[164:167], v[40:43], v[76:79], v[164:167]
    v_mfma_f32_16x16x32_bf16 v[168:171], v[44:47], v[72:75], v[168:171]
    v_mfma_f32_16x16x32_bf16 v[172:175], v[44:47], v[76:79], v[172:175]
    buffer_load_dwordx4 v[208:211], v2, s[16:19], s57 offen offset:0 nt
    buffer_load_dwordx4 v[212:215], v2, s[16:19], s57 offen offset:1024 nt
    buffer_load_dwordx4 v[216:219], v2, s[16:19], s57 offen offset:2048 nt
    buffer_load_dwordx4 v[220:223], v2, s[16:19], s57 offen offset:3072 nt
    s_add_u32 s57, s57, 32768
    buffer_load_dwordx4 v[224:227], v2, s[16:19], s57 offen offset:0 nt
    buffer_load_dwordx4 v[228:231], v2, s[16:19], s57 offen offset:1024 nt
    buffer_load_dwordx4 v[232:235], v2, s[16:19], s57 offen offset:2048 nt
    buffer_load_dwordx4 v[236:239], v2, s[16:19], s57 offen offset:3072 nt
    s_add_u32 s57, s57, 32768
    buffer_load_dwordx4 v[64:67], v2, s[16:19], s57 offen offset:0 nt
    buffer_load_dwordx4 v[68:71], v2, s[16:19], s57 offen offset:1024 nt
    buffer_load_dwordx4 v[72:75], v2, s[16:19], s57 offen offset:2048 nt
    buffer_load_dwordx4 v[76:79], v2, s[16:19], s57 offen offset:3072 nt
    s_add_u32 s57, s57, 32768
    s_waitcnt vmcnt(24)
    v_perm_b32 v32, v180, v176, s53
    v_perm_b32 v33, v188, v184, s53
    v_perm_b32 v34, v20, v16, s53
    v_perm_b32 v35, v28, v24, s53
    v_perm_b32 v36, v180, v176, s54
    v_perm_b32 v37, v188, v184, s54
    v_perm_b32 v38, v20, v16, s54
    v_perm_b32 v39, v28, v24, s54
    v_mfma_f32_16x16x32_bf16 v[112:115], v[32:35], v[80:83], v[112:115]
    v_mfma_f32_16x16x32_bf16 v[116:119], v[32:35], v[84:87], v[116:119]
    v_mfma_f32_16x16x32_bf16 v[120:123], v[36:39], v[80:83], v[120:123]
    v_mfma_f32_16x16x32_bf16 v[124:127], v[36:39], v[84:87], v[124:127]
    v_perm_b32 v40, v181, v177, s53
    v_perm_b32 v41, v189, v185, s53
    v_perm_b32 v42, v21, v17, s53
    v_perm_b32 v43, v29, v25, s53
    v_perm_b32 v44, v181, v177, s54
    v_perm_b32 v45, v189, v185, s54
    v_perm_b32 v46, v21, v17, s54
    v_perm_b32 v47, v29, v25, s54
    v_mfma_f32_16x16x32_bf16 v[128:131], v[40:43], v[80:83], v[128:131]
    v_mfma_f32_16x16x32_bf16 v[132:135], v[40:43], v[84:87], v[132:135]
    v_mfma_f32_16x16x32_bf16 v[136:139], v[44:47], v[80:83], v[136:139]
    v_mfma_f32_16x16x32_bf16 v[140:143], v[44:47], v[84:87], v[140:143]
    v_perm_b32 v32, v182, v178, s53
    v_perm_b32 v33, v190, v186, s53
    v_perm_b32 v34, v22, v18, s53
    v_perm_b32 v35, v30, v26, s53
    v_perm_b32 v36, v182, v178, s54
    v_perm_b32 v37, v190, v186, s54
    v_perm_b32 v38, v22, v18, s54
    v_perm_b32 v39, v30, v26, s54
    v_mfma_f32_16x16x32_bf16 v[144:147], v[32:35], v[80:83], v[144:147]
    v_mfma_f32_16x16x32_bf16 v[148:151], v[32:35], v[84:87], v[148:151]
    v_mfma_f32_16x16x32_bf16 v[152:155], v[36:39], v[80:83], v[152:155]
    v_mfma_f32_16x16x32_bf16 v[156:159], v[36:39], v[84:87], v[156:159]
    v_perm_b32 v40, v183, v179, s53
    v_perm_b32 v41, v191, v187, s53
    v_perm_b32 v42, v23, v19, s53
    v_perm_b32 v43, v31, v27, s53
    v_perm_b32 v44, v183, v179, s54
    v_perm_b32 v45, v191, v187, s54
    v_perm_b32 v46, v23, v19, s54
    v_perm_b32 v47, v31, v27, s54
    v_mfma_f32_16x16x32_bf16 v[160:163], v[40:43], v[80:83], v[160:163]
    v_mfma_f32_16x16x32_bf16 v[164:167], v[40:43], v[84:87], v[164:167]
    v_mfma_f32_16x16x32_bf16 v[168:171], v[44:47], v[80:83], v[168:171]
    v_mfma_f32_16x16x32_bf16 v[172:175], v[44:47], v[84:87], v[172:175]
    s_waitcnt vmcnt(16)
    v_perm_b32 v32, v52, v48, s53
    v_perm_b32 v33, v60, v56, s53
    v_perm_b32 v34, v244, v240, s53
    v_perm_b32 v35, v252, v248, s53
    v_perm_b32 v36, v52, v48, s54
    v_perm_b32 v37, v60, v56, s54
    v_perm_b32 v38, v244, v240, s54
    v_perm_b32 v39, v252, v248, s54
    v_mfma_f32_16x16x32_bf16 v[112:115], v[32:35], v[88:91], v[112:115]
    v_mfma_f32_16x16x32_bf16 v[116:119], v[32:35], v[92:95], v[116:119]
    v_mfma_f32_16x16x32_bf16 v[120:123], v[36:39], v[88:91], v[120:123]
    v_mfma_f32_16x16x32_bf16 v[124:127], v[36:39], v[92:95], v[124:127]
    v_perm_b32 v40, v53, v49, s53
    v_perm_b32 v41, v61, v57, s53
    v_perm_b32 v42, v245, v241, s53
    v_perm_b32 v43, v253, v249, s53
    v_perm_b32 v44, v53, v49, s54
    v_perm_b32 v45, v61, v57, s54
    v_perm_b32 v46, v245, v241, s54
    v_perm_b32 v47, v253, v249, s54
    v_mfma_f32_16x16x32_bf16 v[128:131], v[40:43], v[88:91], v[128:131]
    v_mfma_f32_16x16x32_bf16 v[132:135], v[40:43], v[92:95], v[132:135]
    v_mfma_f32_16x16x32_bf16 v[136:139], v[44:47], v[88:91], v[136:139]
    v_mfma_f32_16x16x32_bf16 v[140:143], v[44:47], v[92:95], v[140:143]
    v_perm_b32 v32, v54, v50, s53
    v_perm_b32 v33, v62, v58, s53
    v_perm_b32 v34, v246, v242, s53
    v_perm_b32 v35, v254, v250, s53
    v_perm_b32 v36, v54, v50, s54
    v_perm_b32 v37, v62, v58, s54
    v_perm_b32 v38, v246, v242, s54
    v_perm_b32 v39, v254, v250, s54
    v_mfma_f32_16x16x32_bf16 v[144:147], v[32:35], v[88:91], v[144:147]
    v_mfma_f32_16x16x32_bf16 v[148:151], v[32:35], v[92:95], v[148:151]
    v_mfma_f32_16x16x32_bf16 v[152:155], v[36:39], v[88:91], v[152:155]
    v_mfma_f32_16x16x32_bf16 v[156:159], v[36:39], v[92:95], v[156:159]
    v_perm_b32 v40, v55, v51, s53
    v_perm_b32 v41, v63, v59, s53
    v_perm_b32 v42, v247, v243, s53
    v_perm_b32 v43, v255, v251, s53
    v_perm_b32 v44, v55, v51, s54
    v_perm_b32 v45, v63, v59, s54
    v_perm_b32 v46, v247, v243, s54
    v_perm_b32 v47, v255, v251, s54
    v_mfma_f32_16x16x32_bf16 v[160:163], v[40:43], v[88:91], v[160:163]
    v_mfma_f32_16x16x32_bf16 v[164:167], v[40:43], v[92:95], v[164:167]
    v_mfma_f32_16x16x32_bf16 v[168:171], v[44:47], v[88:91], v[168:171]
    v_mfma_f32_16x16x32_bf16 v[172:175], v[44:47], v[92:95], v[172:175]
    s_waitcnt vmcnt(8)
    v_perm_b32 v32, v196, v192, s53
    v_perm_b32 v33, v204, v200, s53
    v_perm_b32 v34, v212, v208, s53
    v_perm_b32 v35, v220, v216, s53
    v_perm_b32 v36, v196, v192, s54
    v_perm_b32 v37, v204, v200, s54
    v_perm_b32 v38, v212, v208, s54
    v_perm_b32 v39, v220, v216, s54
    v_mfma_f32_16x16x32_bf16 v[112:115], v[32:35], v[96:99], v[112:115]
    v_mfma_f32_16x16x32_bf16 v[116:119], v[32:35], v[100:103], v[116:119]
    v_mfma_f32_16x16x32_bf16 v[120:123], v[36:39], v[96:99], v[120:123]
    v_mfma_f32_16x16x32_bf16 v[124:127], v[36:39], v[100:103], v[124:127]
    v_perm_b32 v40, v197, v193, s53
    v_perm_b32 v41, v205, v201, s53
    v_perm_b32 v42, v213, v209, s53
    v_perm_b32 v43, v221, v217, s53
    v_perm_b32 v44, v197, v193, s54
    v_perm_b32 v45, v205, v201, s54
    v_perm_b32 v46, v213, v209, s54
    v_perm_b32 v47, v221, v217, s54
    v_mfma_f32_16x16x32_bf16 v[128:131], v[40:43], v[96:99], v[128:131]
    v_mfma_f32_16x16x32_bf16 v[132:135], v[40:43], v[100:103], v[132:135]
    v_mfma_f32_16x16x32_bf16 v[136:139], v[44:47], v[96:99], v[136:139]
    v_mfma_f32_16x16x32_bf16 v[140:143], v[44:47], v[100:103], v[140:143]
    v_perm_b32 v32, v198, v194, s53
    v_perm_b32 v33, v206, v202, s53
    v_perm_b32 v34, v214, v210, s53
    v_perm_b32 v35, v222, v218, s53
    v_perm_b32 v36, v198, v194, s54
    v_perm_b32 v37, v206, v202, s54
    v_perm_b32 v38, v214, v210, s54
    v_perm_b32 v39, v222, v218, s54
    v_mfma_f32_16x16x32_bf16 v[144:147], v[32:35], v[96:99], v[144:147]
    v_mfma_f32_16x16x32_bf16 v[148:151], v[32:35], v[100:103], v[148:151]
    v_mfma_f32_16x16x32_bf16 v[152:155], v[36:39], v[96:99], v[152:155]
    v_mfma_f32_16x16x32_bf16 v[156:159], v[36:39], v[100:103], v[156:159]
    v_perm_b32 v40, v199, v195, s53
    v_perm_b32 v41, v207, v203, s53
    v_perm_b32 v42, v215, v211, s53
    v_perm_b32 v43, v223, v219, s53
    v_perm_b32 v44, v199, v195, s54
    v_perm_b32 v45, v207, v203, s54
    v_perm_b32 v46, v215, v211, s54
    v_perm_b32 v47, v223, v219, s54
    v_mfma_f32_16x16x32_bf16 v[160:163], v[40:43], v[96:99], v[160:163]
    v_mfma_f32_16x16x32_bf16 v[164:167], v[40:43], v[100:103], v[164:167]
    v_mfma_f32_16x16x32_bf16 v[168:171], v[44:47], v[96:99], v[168:171]
    v_mfma_f32_16x16x32_bf16 v[172:175], v[44:47], v[100:103], v[172:175]
    s_waitcnt vmcnt(0)
    v_perm_b32 v32, v228, v224, s53
    v_perm_b32 v33, v236, v232, s53
    v_perm_b32 v34, v68, v64, s53
    v_perm_b32 v35, v76, v72, s53
    v_perm_b32 v36, v228, v224, s54
    v_perm_b32 v37, v236, v232, s54
    v_perm_b32 v38, v68, v64, s54
    v_perm_b32 v39, v76, v72, s54
    v_mfma_f32_16x16x32_bf16 v[112:115], v[32:35], v[104:107], v[112:115]
    v_mfma_f32_16x16x32_bf16 v[116:119], v[32:35], v[108:111], v[116:119]
    v_mfma_f32_16x16x32_bf16 v[120:123], v[36:39], v[104:107], v[120:123]
    v_mfma_f32_16x16x32_bf16 v[124:127], v[36:39], v[108:111], v[124:127]
    v_perm_b32 v40, v229, v225, s53
    v_perm_b32 v41, v237, v233, s53
    v_perm_b32 v42, v69, v65, s53
    v_perm_b32 v43, v77, v73, s53
    v_perm_b32 v44, v229, v225, s54
    v_perm_b32 v45, v237, v233, s54
    v_perm_b32 v46, v69, v65, s54
    v_perm_b32 v47, v77, v73, s54
    ds_write_b128 v1, v[112:115] offset:0
    ds_write_b128 v1, v[116:119] offset:8448
    ds_write_b128 v1, v[120:123] offset:16
    ds_write_b128 v1, v[124:127] offset:8464
    v_mfma_f32_16x16x32_bf16 v[128:131], v[40:43], v[104:107], v[128:131]
    v_mfma_f32_16x16x32_bf16 v[132:135], v[40:43], v[108:111], v[132:135]
    v_mfma_f32_16x16x32_bf16 v[136:139], v[44:47], v[104:107], v[136:139]
    v_mfma_f32_16x16x32_bf16 v[140:143], v[44:47], v[108:111], v[140:143]
    v_perm_b32 v32, v230, v226, s53
    v_perm_b32 v33, v238, v234, s53
    v_perm_b32 v34, v70, v66, s53
    v_perm_b32 v35, v78, v74, s53
    v_perm_b32 v36, v230, v226, s54
    v_perm_b32 v37, v238, v234, s54
    v_perm_b32 v38, v70, v66, s54
    v_perm_b32 v39, v78, v74, s54
    ds_write_b128 v1, v[128:131] offset:32
    ds_write_b128 v1, v[132:135] offset:8480
    ds_write_b128 v1, v[136:139] offset:48
    ds_write_b128 v1, v[140:143] offset:8496
    v_mfma_f32_16x16x32_bf16 v[144:147], v[32:35], v[104:107], v[144:147]
    v_mfma_f32_16x16x32_bf16 v[148:151], v[32:35], v[108:111], v[148:151]
    v_mfma_f32_16x16x32_bf16 v[152:155], v[36:39], v[104:107], v[152:155]
    v_mfma_f32_16x16x32_bf16 v[156:159], v[36:39], v[108:111], v[156:159]
    v_perm_b32 v40, v231, v227, s53
    v_perm_b32 v41, v239, v235, s53
    v_perm_b32 v42, v71, v67, s53
    v_perm_b32 v43, v79, v75, s53
    v_perm_b32 v44, v231, v227, s54
    v_perm_b32 v45, v239, v235, s54
    v_perm_b32 v46, v71, v67, s54
    v_perm_b32 v47, v79, v75, s54
    ds_write_b128 v1, v[144:147] offset:64
    ds_write_b128 v1, v[148:151] offset:8512
    ds_write_b128 v1, v[152:155] offset:80
    ds_write_b128 v1, v[156:159] offset:8528
    v_mfma_f32_16x16x32_bf16 v[160:163], v[40:43], v[104:107], v[160:163]
    v_mfma_f32_16x16x32_bf16 v[164:167], v[40:43], v[108:111], v[164:167]
    v_mfma_f32_16x16x32_bf16 v[168:171], v[44:47], v[104:107], v[168:171]
    v_mfma_f32_16x16x32_bf16 v[172:175], v[44:47], v[108:111], v[172:175]
    s_nop 7
    ds_write_b128 v1, v[160:163] offset:96
    ds_write_b128 v1, v[164:167] offset:8544
    ds_write_b128 v1, v[168:171] offset:112
    ds_write_b128 v1, v[172:175] offset:8560
    s_waitcnt lgkmcnt(0)
    s_barrier
    ds_read_b64 v[16:17], v14 offset:0
    ds_read_b64 v[18:19], v14 offset:256
    ds_read_b64 v[20:21], v14 offset:512
    ds_read_b64 v[22:23], v14 offset:768
    ds_read_b64 v[24:25], v14 offset:1024
    ds_read_b64 v[26:27], v14 offset:1280
    ds_read_b64 v[28:29], v14 offset:1536
    ds_read_b64 v[30:31], v14 offset:1792
    ds_read_b128 v[32:35], v3 offset:0
    ds_read_b128 v[36:39], v3 offset:16
    ds_read_b128 v[40:43], v3 offset:16896
    ds_read_b128 v[44:47], v3 offset:16912
    ds_read_b128 v[48:51], v3 offset:33792
    ds_read_b128 v[52:55], v3 offset:33808
    s_waitcnt lgkmcnt(6)
    ds_read_b128 v[56:59], v3 offset:50688
    ds_read_b128 v[60:63], v3 offset:50704
    ds_read_b128 v[64:67], v4 offset:0
    ds_read_b128 v[68:71], v4 offset:16
    ds_read_b128 v[72:75], v4 offset:16896
    ds_read_b128 v[76:79], v4 offset:16912
    ds_read_b128 v[80:83], v4 offset:33792
    ds_read_b128 v[84:87], v4 offset:33808
    v_max_f32 v184, v16, v18
    v_max3_f32 v184, v184, v20, v22
    v_max3_f32 v184, v184, v24, v26
    v_max3_f32 v184, v184, v28, v30
    v_mul_f32 v184, s52, v184
    v_fma_f32 v176, v16, s52, -v184
    v_fma_f32 v177, v18, s52, -v184
    v_fma_f32 v178, v20, s52, -v184
    v_fma_f32 v179, v22, s52, -v184
    v_fma_f32 v180, v24, s52, -v184
    v_fma_f32 v181, v26, s52, -v184
    v_fma_f32 v182, v28, s52, -v184
    v_fma_f32 v183, v30, s52, -v184
    v_exp_f32 v176, v176
    v_exp_f32 v177, v177
    v_exp_f32 v178, v178
    v_exp_f32 v179, v179
    v_exp_f32 v180, v180
    v_exp_f32 v181, v181
    v_exp_f32 v182, v182
    v_exp_f32 v183, v183
    s_nop 0
    v_mul_f32 v185, v176, v17
    v_fma_f32 v185, v177, v19, v185
    v_fma_f32 v185, v178, v21, v185
    v_fma_f32 v185, v179, v23, v185
    v_fma_f32 v185, v180, v25, v185
    v_fma_f32 v185, v181, v27, v185
    v_fma_f32 v185, v182, v29, v185
    v_fma_f32 v185, v183, v31, v185
    v_rcp_f32 v185, v185
    s_waitcnt lgkmcnt(8)
    ds_read_b128 v[88:91], v4 offset:50688
    ds_read_b128 v[92:95], v4 offset:50704
    v_pk_mul_f32 v[192:193], v[32:33], v[176:177] op_sel_hi:[1,0]
    v_pk_mul_f32 v[194:195], v[34:35], v[176:177] op_sel_hi:[1,0]
    v_pk_mul_f32 v[196:197], v[36:37], v[176:177] op_sel_hi:[1,0]
    v_pk_mul_f32 v[198:199], v[38:39], v[176:177] op_sel_hi:[1,0]
    v_pk_fma_f32 v[192:193], v[40:41], v[176:177], v[192:193] op_sel:[0,1,0] op_sel_hi:[1,1,1]
    v_pk_fma_f32 v[194:195], v[42:43], v[176:177], v[194:195] op_sel:[0,1,0] op_sel_hi:[1,1,1]
    v_pk_fma_f32 v[196:197], v[44:45], v[176:177], v[196:197] op_sel:[0,1,0] op_sel_hi:[1,1,1]
    v_pk_fma_f32 v[198:199], v[46:47], v[176:177], v[198:199] op_sel:[0,1,0] op_sel_hi:[1,1,1]
    v_pk_fma_f32 v[192:193], v[48:49], v[178:179], v[192:193] op_sel_hi:[1,0,1]
    v_pk_fma_f32 v[194:195], v[50:51], v[178:179], v[194:195] op_sel_hi:[1,0,1]
    v_pk_fma_f32 v[196:197], v[52:53], v[178:179], v[196:197] op_sel_hi:[1,0,1]
    v_pk_fma_f32 v[198:199], v[54:55], v[178:179], v[198:199] op_sel_hi:[1,0,1]
    s_waitcnt lgkmcnt(8)
    v_pk_fma_f32 v[192:193], v[56:57], v[178:179], v[192:193] op_sel:[0,1,0] op_sel_hi:[1,1,1]
    v_pk_fma_f32 v[194:195], v[58:59], v[178:179], v[194:195] op_sel:[0,1,0] op_sel_hi:[1,1,1]
    v_pk_fma_f32 v[196:197], v[60:61], v[178:179], v[196:197] op_sel:[0,1,0] op_sel_hi:[1,1,1]
    v_pk_fma_f32 v[198:199], v[62:63], v[178:179], v[198:199] op_sel:[0,1,0] op_sel_hi:[1,1,1]
    s_waitcnt lgkmcnt(6)
    v_pk_fma_f32 v[192:193], v[64:65], v[180:181], v[192:193] op_sel_hi:[1,0,1]
    v_pk_fma_f32 v[194:195], v[66:67], v[180:181], v[194:195] op_sel_hi:[1,0,1]
    v_pk_fma_f32 v[196:197], v[68:69], v[180:181], v[196:197] op_sel_hi:[1,0,1]
    v_pk_fma_f32 v[198:199], v[70:71], v[180:181], v[198:199] op_sel_hi:[1,0,1]
    s_waitcnt lgkmcnt(4)
    v_pk_fma_f32 v[192:193], v[72:73], v[180:181], v[192:193] op_sel:[0,1,0] op_sel_hi:[1,1,1]
    v_pk_fma_f32 v[194:195], v[74:75], v[180:181], v[194:195] op_sel:[0,1,0] op_sel_hi:[1,1,1]
    v_pk_fma_f32 v[196:197], v[76:77], v[180:181], v[196:197] op_sel:[0,1,0] op_sel_hi:[1,1,1]
    v_pk_fma_f32 v[198:199], v[78:79], v[180:181], v[198:199] op_sel:[0,1,0] op_sel_hi:[1,1,1]
    s_waitcnt lgkmcnt(2)
    v_pk_fma_f32 v[192:193], v[80:81], v[182:183], v[192:193] op_sel_hi:[1,0,1]
    v_pk_fma_f32 v[194:195], v[82:83], v[182:183], v[194:195] op_sel_hi:[1,0,1]
    v_pk_fma_f32 v[196:197], v[84:85], v[182:183], v[196:197] op_sel_hi:[1,0,1]
    v_pk_fma_f32 v[198:199], v[86:87], v[182:183], v[198:199] op_sel_hi:[1,0,1]
    s_waitcnt lgkmcnt(0)
    v_pk_fma_f32 v[192:193], v[88:89], v[182:183], v[192:193] op_sel:[0,1,0] op_sel_hi:[1,1,1]
    v_pk_fma_f32 v[194:195], v[90:91], v[182:183], v[194:195] op_sel:[0,1,0] op_sel_hi:[1,1,1]
    v_pk_fma_f32 v[196:197], v[92:93], v[182:183], v[196:197] op_sel:[0,1,0] op_sel_hi:[1,1,1]
    v_pk_fma_f32 v[198:199], v[94:95], v[182:183], v[198:199] op_sel:[0,1,0] op_sel_hi:[1,1,1]
    v_mul_f32 v192, v192, v185
    v_mul_f32 v193, v193, v185
    v_mul_f32 v194, v194, v185
    v_mul_f32 v195, v195, v185
    v_mul_f32 v196, v196, v185
    v_mul_f32 v197, v197, v185
    v_mul_f32 v198, v198, v185
    v_mul_f32 v199, v199, v185
    v_cvt_pk_bf16_f32 v200, v192, v196
    v_cvt_pk_bf16_f32 v201, v193, v197
    v_cvt_pk_bf16_f32 v202, v194, v198
    v_cvt_pk_bf16_f32 v203, v195, v199
    s_mov_b32 s58, 0xcccccccc
    s_mov_b32 s59, 0xcccccccc
    s_mov_b64 exec, s[62:63]
    v_swap_b32 v200, v201
    v_swap_b32 v202, v203
    s_mov_b64 exec, -1
    s_nop 1
    v_mov_b32_dpp v201, v201 quad_perm:[1,0,3,2] row_mask:0xf bank_mask:0xf
    v_mov_b32_dpp v203, v203 quad_perm:[1,0,3,2] row_mask:0xf bank_mask:0xf
    s_mov_b64 exec, s[62:63]
    v_swap_b32 v200, v201
    v_swap_b32 v202, v203
    s_mov_b64 exec, s[58:59]
    v_swap_b32 v200, v202
    v_swap_b32 v201, v203
    s_mov_b64 exec, -1
    s_nop 1
    v_mov_b32_dpp v202, v202 quad_perm:[2,3,0,1] row_mask:0xf bank_mask:0xf
    v_mov_b32_dpp v203, v203 quad_perm:[2,3,0,1] row_mask:0xf bank_mask:0xf
    s_mov_b64 exec, s[58:59]
    v_swap_b32 v200, v202
    v_swap_b32 v201, v203
    s_mov_b64 exec, -1
    v_lshlrev_b32 v15, 4, v0
    buffer_store_dwordx4 v[200:203], v15, s[32:35], 0 offen nt
L_end:
    s_endpgm
.section .rodata,"a"
.p2align 6
.amdhsa_kernel standalone__tree_speculative_verify_tree_attention_over_candidate_token_tree__sampling_kernel
  .amdhsa_next_free_vgpr 256
  .amdhsa_next_free_sgpr 64
  .amdhsa_accum_offset 256
  .amdhsa_group_segment_fixed_size 0
  .amdhsa_kernarg_size 72
  .amdhsa_user_sgpr_count 2
  .amdhsa_user_sgpr_kernarg_segment_ptr 1
  .amdhsa_system_sgpr_workgroup_id_x 1
.end_amdhsa_kernel
```
